```python
import torch

def _softmax(x, axis=-1):
    return torch.softmax(x, dim=axis)
def _gelu(x):
    return torch.nn.functional.gelu(x, approximate="tanh")
def _silu(x):
    return torch.nn.functional.silu(x)
def _sigmoid(x):
    return torch.sigmoid(x)
def _layernorm(x, axis=-1, eps=1e-5):
    m = x.mean(dim=axis, keepdim=True)
    v = x.var(dim=axis, keepdim=True, unbiased=False)
    return (x - m) / torch.sqrt(v + eps)
def _scatter_add(tgt, idx, src, axis=0):
    return tgt.clone().index_add_(axis, idx, src)
def _segment_sum(src, seg, n):
    out = torch.zeros((n,) + src.shape[1:], dtype=src.dtype)
    return out.index_add_(0, seg, src)
def _pad(x, pw):
    flat = tuple(v for pair in reversed(pw) for v in pair)
    return torch.nn.functional.pad(x, flat)

kernel_name = 'gated_mix__grouped_kv_mqa__mixer_token_mlp__prompt'

def setup_inputs():

    _w = (lambda a: (lambda t: t.to(torch.bfloat16) if t.is_floating_point() else t)(torch.as_tensor(a)))
    def _A_setup():
        B, S, D, H = 1, 2048, 448, 16
        Dh = D // H
        return {
            "x": _w((lambda *s: torch.randn(*s, dtype=torch.bfloat16) * 0.05)(B, S, D)),
            "wq": _w((lambda *s: torch.randn(*s, dtype=torch.bfloat16) * 1.6)(D, H * Dh)),
            "wk": _w((lambda *s: torch.randn(*s, dtype=torch.bfloat16) * 1.6)(D, Dh)),
            "wv": _w((lambda *s: torch.randn(*s, dtype=torch.bfloat16) * 0.05)(D, Dh)),
            "wo": _w((lambda *s: torch.randn(*s, dtype=torch.bfloat16) * 0.05)(H * Dh, D)),
        }
    _A_in = _A_setup()

    def _B_setup():
        B, S, D, F = 1, 2048, 448, 1792
        return {
            "x": _w((lambda *s: torch.randn(*s, dtype=torch.bfloat16) * 0.05)(B, S, D)),
            "w1": _w((lambda *s: torch.randn(*s, dtype=torch.bfloat16) * 0.8)(S, F) * (S ** -0.5)),
            "b1": _w((lambda *s: torch.randn(*s, dtype=torch.bfloat16) * 12.8)(F) * 0.02),
            "w2": _w((lambda *s: torch.randn(*s, dtype=torch.bfloat16) * 0.05)(F, S) * (F ** -0.5)),
            "b2": _w((lambda *s: torch.randn(*s, dtype=torch.bfloat16) * 0.4)(S) * 0.02),
        }
    _B_in = _B_setup()

    return {
        "A_x": _A_in["x"],
        "A_wq": _A_in["wq"],
        "A_wk": _A_in["wk"],
        "A_wv": _A_in["wv"],
        "A_wo": _A_in["wo"],
        "B_x": _B_in["x"],
        "B_w1": _B_in["w1"],
        "B_b1": _B_in["b1"],
        "B_w2": _B_in["w2"],
        "B_b2": _B_in["b2"],
        "gate_w": _w((lambda *s: torch.randn(*s, dtype=torch.bfloat16) * 0.05)(448) * 16.0),
    }

def reference(A_x, A_wq, A_wk, A_wv, A_wo, B_x, B_w1, B_b1, B_w2, B_b2, gate_w):
    def _A_ref(x, wq, wk, wv, wo):
        B, S, D = x.shape
        H = 16
        Dh = D // H
        q = (lambda x, *d: x.permute(*d))((x @ wq).reshape(B, S, H, Dh), 0, 2, 1, 3)
        k = x @ wk
        v = x @ wv
        scores = torch.einsum("bhqd,bkd->bhqk", q, k) * (Dh ** -0.5)
        p = _softmax(scores, axis=-1)
        o = torch.einsum("bhqk,bkd->bhqd", p, v)
        return (lambda x, *d: x.permute(*d))(o, 0, 2, 1, 3).reshape(B, S, H * Dh) @ wo

    def _B_ref(x, w1, b1, w2, b2):
        B, S, D = x.shape
        h = _layernorm(x, axis=-1)
        u = torch.einsum("bsd,sf->bdf", h, w1) + b1
        u = _gelu(u)
        y = torch.einsum("bdf,fs->bds", u, w2) + b2
        return (lambda x, *d: x.permute(*d))(y, 0, 2, 1)

    x = A_x
    g = _sigmoid((x * gate_w).sum(-1, keepdims=True))
    a = _A_ref(x, A_wq, A_wk, A_wv, A_wo)
    b = _B_ref(x, B_w1, B_b1, B_w2, B_b2)
    return g * a + (1 - g) * b
```

```asm
; @launch kernel=k1_kernel grid=(256,1,1) block=(512,1,1) lds=155648
; @launch kernel=k2_kernel grid=(256,1,1) block=(512,1,1) lds=147520
.amdgcn_target "amdgcn-amd-amdhsa--gfx950"
.text
    .globl k1_kernel
    .p2align 8
    .type k1_kernel,@function
k1_kernel:
    s_cmp_ge_u32 s2, 256
    s_cbranch_scc1 K1_END
    s_load_dwordx4 s[4:7], s[0:1], 0
    s_load_dwordx4 s[8:11], s[0:1], 16
    s_load_dwordx2 s[12:13], s[0:1], 80
    s_load_dwordx2 s[14:15], s[0:1], 104
    s_load_dwordx2 s[48:49], s[0:1], 48
    s_load_dwordx2 s[76:77], s[0:1], 32
    v_lshrrev_b32 v2, 6, v0
    v_and_b32 v1, 63, v0
    s_and_b32 s17, s2, 7
    v_readfirstlane_b32 s16, v2
    s_lshl_b32 s17, s17, 3
    s_lshr_b32 s18, s2, 5
    s_add_u32 s17, s17, s18
    s_bfe_u32 s18, s2, 0x20003
    v_lshlrev_b32 v2, 4, v1
    s_lshl_b32 s40, s17, 5
    s_lshl_b32 s41, s16, 2
    s_add_u32 s40, s40, s41
    s_mul_i32 s40, s40, 896
    s_mul_i32 s41, s41, 912
    v_mul_u32_u24 v3, 4682, v0
    v_lshrrev_b32 v3, 16, v3
    v_mul_u32_u24 v4, 14, v3
    v_sub_u32 v4, v0, v4
    v_mul_u32_u24 v5, 896, v3
    v_lshl_add_u32 v5, v4, 4, v5
    s_mul_i32 s42, s18, 224
    s_lshl_b32 s43, s16, 10
    s_waitcnt lgkmcnt(0)
    s_mov_b32 s20, s4
    s_mov_b32 s21, s5
    s_mov_b32 s22, 1835008
    s_mov_b32 s23, 0x20000
    s_mov_b32 s24, s6
    s_mov_b32 s25, s7
    s_mov_b32 s26, 401408
    s_mov_b32 s27, 0x20000
    s_mov_b32 s36, s14
    s_mov_b32 s37, s15
    s_mov_b32 s38, 8388608
    s_mov_b32 s39, 0x20000
    s_cmp_lg_u32 s16, 7
    s_cbranch_scc1 K1_NZ
    s_lshl_b32 s44, s2, 7
    s_add_u32 s44, s44, 5898240
    v_mov_b32 v6, 0
    v_lshlrev_b32 v7, 2, v1
    s_mov_b64 exec, 15
    buffer_store_dword v6, v7, s[36:39], s44 offen
    s_add_u32 s44, s44, 32768
    buffer_store_dword v6, v7, s[36:39], s44 offen
K1_NZ:
    s_mov_b32 exec_lo, -1
    s_mov_b32 exec_hi, 0xffffff
    s_add_u32 m0, s41, 0
    s_add_u32 s44, s40, 0
    buffer_load_dwordx4 v2, s[20:23], s44 offen lds
    s_add_u32 m0, s41, 912
    s_add_u32 s44, s40, 896
    buffer_load_dwordx4 v2, s[20:23], s44 offen lds
    s_add_u32 m0, s41, 1824
    s_add_u32 s44, s40, 1792
    buffer_load_dwordx4 v2, s[20:23], s44 offen lds
    s_add_u32 m0, s41, 2736
    s_add_u32 s44, s40, 2688
    buffer_load_dwordx4 v2, s[20:23], s44 offen lds
    s_mov_b32 exec_hi, -1
    s_cmp_lt_u32 s16, 4
    s_cbranch_scc1 K1_WQ
    s_cmp_lt_u32 s18, 2
    s_cbranch_scc1 K1_NOLN0
    s_mov_b32 s32, s12
    s_mov_b32 s33, s13
    s_mov_b32 s34, 896
    s_mov_b32 s35, 0x20000
    s_sub_u32 s45, s16, 4
    s_lshl_b32 s45, s45, 2
    v_lshrrev_b32 v6, 4, v1
    v_add_u32 v6, s45, v6
    v_and_b32 v7, 15, v1
    v_lshlrev_b32 v7, 3, v7
    v_mul_u32_u24 v8, 896, v6
    v_add_u32 v8, v8, v7
    s_lshl_b32 s46, s17, 1
    s_add_u32 s46, s46, s18
    s_sub_u32 s46, s46, 2
    s_mul_i32 s47, s46, 14336
    buffer_load_dwordx2 v[16:17], v8, s[20:23], s47 offen offset:0
    buffer_load_dwordx2 v[18:19], v8, s[20:23], s47 offen offset:128
    buffer_load_dwordx2 v[20:21], v8, s[20:23], s47 offen offset:256
    buffer_load_dwordx2 v[22:23], v8, s[20:23], s47 offen offset:384
    buffer_load_dwordx2 v[24:25], v8, s[20:23], s47 offen offset:512
    buffer_load_dwordx2 v[26:27], v8, s[20:23], s47 offen offset:640
    buffer_load_dwordx2 v[28:29], v8, s[20:23], s47 offen offset:768
    buffer_load_dwordx2 v[64:65], v7, s[32:35], 0 offen offset:0
    buffer_load_dwordx2 v[66:67], v7, s[32:35], 0 offen offset:128
    buffer_load_dwordx2 v[68:69], v7, s[32:35], 0 offen offset:256
    buffer_load_dwordx2 v[70:71], v7, s[32:35], 0 offen offset:384
    buffer_load_dwordx2 v[72:73], v7, s[32:35], 0 offen offset:512
    buffer_load_dwordx2 v[74:75], v7, s[32:35], 0 offen offset:640
    buffer_load_dwordx2 v[76:77], v7, s[32:35], 0 offen offset:768
K1_NOLN0:
    s_cmp_eq_u32 s16, 7
    s_cbranch_scc1 K1_W7
K1_WQ:
    s_lshr_b32 s56, s2, 5
    s_mul_i32 s56, s56, 7
    s_lshr_b32 s56, s56, 2
    s_mul_i32 s56, s56, 7168
    s_add_u32 s43, s43, 29184
    s_add_u32 m0, s43, s56
    s_lshl2_add_u32 s44, s56, s42
    buffer_load_dwordx4 v5, s[24:27], s44 offen lds
    s_add_u32 s56, s56, 7168
    s_cmp_eq_u32 s56, 100352
    s_cselect_b32 s56, 0, s56
    s_add_u32 m0, s43, s56
    s_lshl2_add_u32 s44, s56, s42
    buffer_load_dwordx4 v5, s[24:27], s44 offen lds
    s_add_u32 s56, s56, 7168
    s_cmp_eq_u32 s56, 100352
    s_cselect_b32 s56, 0, s56
    s_add_u32 m0, s43, s56
    s_lshl2_add_u32 s44, s56, s42
    buffer_load_dwordx4 v5, s[24:27], s44 offen lds
    s_add_u32 s56, s56, 7168
    s_cmp_eq_u32 s56, 100352
    s_cselect_b32 s56, 0, s56
    s_add_u32 m0, s43, s56
    s_lshl2_add_u32 s44, s56, s42
    buffer_load_dwordx4 v5, s[24:27], s44 offen lds
    s_add_u32 s56, s56, 7168
    s_cmp_eq_u32 s56, 100352
    s_cselect_b32 s56, 0, s56
    s_add_u32 m0, s43, s56
    s_lshl2_add_u32 s44, s56, s42
    buffer_load_dwordx4 v5, s[24:27], s44 offen lds
    s_add_u32 s56, s56, 7168
    s_cmp_eq_u32 s56, 100352
    s_cselect_b32 s56, 0, s56
    s_add_u32 m0, s43, s56
    s_lshl2_add_u32 s44, s56, s42
    buffer_load_dwordx4 v5, s[24:27], s44 offen lds
    s_add_u32 s56, s56, 7168
    s_cmp_eq_u32 s56, 100352
    s_cselect_b32 s56, 0, s56
    s_add_u32 m0, s43, s56
    s_lshl2_add_u32 s44, s56, s42
    buffer_load_dwordx4 v5, s[24:27], s44 offen lds
    s_add_u32 s56, s56, 7168
    s_cmp_eq_u32 s56, 100352
    s_cselect_b32 s56, 0, s56
    s_add_u32 m0, s43, s56
    s_lshl2_add_u32 s44, s56, s42
    buffer_load_dwordx4 v5, s[24:27], s44 offen lds
    s_add_u32 s56, s56, 7168
    s_cmp_eq_u32 s56, 100352
    s_cselect_b32 s56, 0, s56
    s_add_u32 m0, s43, s56
    s_lshl2_add_u32 s44, s56, s42
    buffer_load_dwordx4 v5, s[24:27], s44 offen lds
    s_add_u32 s56, s56, 7168
    s_cmp_eq_u32 s56, 100352
    s_cselect_b32 s56, 0, s56
    s_add_u32 m0, s43, s56
    s_lshl2_add_u32 s44, s56, s42
    buffer_load_dwordx4 v5, s[24:27], s44 offen lds
    s_add_u32 s56, s56, 7168
    s_cmp_eq_u32 s56, 100352
    s_cselect_b32 s56, 0, s56
    s_add_u32 m0, s43, s56
    s_lshl2_add_u32 s44, s56, s42
    buffer_load_dwordx4 v5, s[24:27], s44 offen lds
    s_add_u32 s56, s56, 7168
    s_cmp_eq_u32 s56, 100352
    s_cselect_b32 s56, 0, s56
    s_add_u32 m0, s43, s56
    s_lshl2_add_u32 s44, s56, s42
    buffer_load_dwordx4 v5, s[24:27], s44 offen lds
    s_add_u32 s56, s56, 7168
    s_cmp_eq_u32 s56, 100352
    s_cselect_b32 s56, 0, s56
    s_add_u32 m0, s43, s56
    s_lshl2_add_u32 s44, s56, s42
    buffer_load_dwordx4 v5, s[24:27], s44 offen lds
    s_add_u32 s56, s56, 7168
    s_cmp_eq_u32 s56, 100352
    s_cselect_b32 s56, 0, s56
    s_add_u32 m0, s43, s56
    s_lshl2_add_u32 s44, s56, s42
    buffer_load_dwordx4 v5, s[24:27], s44 offen lds
    s_cmp_lt_u32 s16, 4
    s_cbranch_scc1 K1_BAR
    s_cmp_lt_u32 s18, 2
    s_cbranch_scc1 K1_BAR
    s_branch K1_LN0
K1_W7:
    s_cmp_ge_u32 s18, 2
    s_cbranch_scc1 K1_LN0
    s_cmp_eq_u32 s18, 0
    s_cselect_b32 s28, s8, s10
    s_cselect_b32 s29, s9, s11
    s_mov_b32 s30, 25088
    s_mov_b32 s31, 0x20000
    s_mov_b32 m0, 129536
    s_mov_b32 s44, 0
    buffer_load_dwordx4 v2, s[28:31], s44 offen offset:0 lds
    buffer_load_dwordx4 v2, s[28:31], s44 offen offset:1024 lds
    buffer_load_dwordx4 v2, s[28:31], s44 offen offset:2048 lds
    buffer_load_dwordx4 v2, s[28:31], s44 offen offset:3072 lds
    s_mov_b32 m0, 133632
    s_mov_b32 s44, 4096
    buffer_load_dwordx4 v2, s[28:31], s44 offen offset:0 lds
    buffer_load_dwordx4 v2, s[28:31], s44 offen offset:1024 lds
    buffer_load_dwordx4 v2, s[28:31], s44 offen offset:2048 lds
    buffer_load_dwordx4 v2, s[28:31], s44 offen offset:3072 lds
    s_mov_b32 m0, 137728
    s_mov_b32 s44, 8192
    buffer_load_dwordx4 v2, s[28:31], s44 offen offset:0 lds
    buffer_load_dwordx4 v2, s[28:31], s44 offen offset:1024 lds
    buffer_load_dwordx4 v2, s[28:31], s44 offen offset:2048 lds
    buffer_load_dwordx4 v2, s[28:31], s44 offen offset:3072 lds
    s_mov_b32 m0, 141824
    s_mov_b32 s44, 12288
    buffer_load_dwordx4 v2, s[28:31], s44 offen offset:0 lds
    buffer_load_dwordx4 v2, s[28:31], s44 offen offset:1024 lds
    buffer_load_dwordx4 v2, s[28:31], s44 offen offset:2048 lds
    buffer_load_dwordx4 v2, s[28:31], s44 offen offset:3072 lds
    s_mov_b32 m0, 145920
    s_mov_b32 s44, 16384
    buffer_load_dwordx4 v2, s[28:31], s44 offen offset:0 lds
    buffer_load_dwordx4 v2, s[28:31], s44 offen offset:1024 lds
    buffer_load_dwordx4 v2, s[28:31], s44 offen offset:2048 lds
    buffer_load_dwordx4 v2, s[28:31], s44 offen offset:3072 lds
    s_mov_b32 m0, 150016
    s_mov_b32 s44, 20480
    buffer_load_dwordx4 v2, s[28:31], s44 offen offset:0 lds
    buffer_load_dwordx4 v2, s[28:31], s44 offen offset:1024 lds
    buffer_load_dwordx4 v2, s[28:31], s44 offen offset:2048 lds
    buffer_load_dwordx4 v2, s[28:31], s44 offen offset:3072 lds
    s_mov_b32 m0, 154112
    s_mov_b32 s44, 24576
    buffer_load_dwordx4 v2, s[28:31], s44 offen offset:0 lds
    s_branch K1_BAR
K1_LN0:
K1_LN1:
    s_mov_b64 exec, -1
    s_waitcnt vmcnt(14)
    s_cmp_lg_u32 s16, 7
    s_cbranch_scc1 K1_LN
    s_waitcnt vmcnt(0)
K1_LN:
    v_mov_b32 v62, 0
    v_mov_b32 v60, 0
    v_mov_b32 v61, 0
    v_lshlrev_b32 v32, 16, v16
    v_and_b32 v33, 0xffff0000, v16
    v_dot2_f32_bf16 v62, v16, v64, v62
    v_pk_add_f32 v[60:61], v[60:61], v[32:33]
    v_lshlrev_b32 v34, 16, v17
    v_and_b32 v35, 0xffff0000, v17
    v_dot2_f32_bf16 v62, v17, v65, v62
    v_pk_add_f32 v[60:61], v[60:61], v[34:35]
    v_lshlrev_b32 v36, 16, v18
    v_and_b32 v37, 0xffff0000, v18
    v_dot2_f32_bf16 v62, v18, v66, v62
    v_pk_add_f32 v[60:61], v[60:61], v[36:37]
    v_lshlrev_b32 v38, 16, v19
    v_and_b32 v39, 0xffff0000, v19
    v_dot2_f32_bf16 v62, v19, v67, v62
    v_pk_add_f32 v[60:61], v[60:61], v[38:39]
    v_lshlrev_b32 v40, 16, v20
    v_and_b32 v41, 0xffff0000, v20
    v_dot2_f32_bf16 v62, v20, v68, v62
    v_pk_add_f32 v[60:61], v[60:61], v[40:41]
    v_lshlrev_b32 v42, 16, v21
    v_and_b32 v43, 0xffff0000, v21
    v_dot2_f32_bf16 v62, v21, v69, v62
    v_pk_add_f32 v[60:61], v[60:61], v[42:43]
    v_lshlrev_b32 v44, 16, v22
    v_and_b32 v45, 0xffff0000, v22
    v_dot2_f32_bf16 v62, v22, v70, v62
    v_pk_add_f32 v[60:61], v[60:61], v[44:45]
    v_lshlrev_b32 v46, 16, v23
    v_and_b32 v47, 0xffff0000, v23
    v_dot2_f32_bf16 v62, v23, v71, v62
    v_pk_add_f32 v[60:61], v[60:61], v[46:47]
    v_lshlrev_b32 v48, 16, v24
    v_and_b32 v49, 0xffff0000, v24
    v_dot2_f32_bf16 v62, v24, v72, v62
    v_pk_add_f32 v[60:61], v[60:61], v[48:49]
    v_lshlrev_b32 v50, 16, v25
    v_and_b32 v51, 0xffff0000, v25
    v_dot2_f32_bf16 v62, v25, v73, v62
    v_pk_add_f32 v[60:61], v[60:61], v[50:51]
    v_lshlrev_b32 v52, 16, v26
    v_and_b32 v53, 0xffff0000, v26
    v_dot2_f32_bf16 v62, v26, v74, v62
    v_pk_add_f32 v[60:61], v[60:61], v[52:53]
    v_lshlrev_b32 v54, 16, v27
    v_and_b32 v55, 0xffff0000, v27
    v_dot2_f32_bf16 v62, v27, v75, v62
    v_pk_add_f32 v[60:61], v[60:61], v[54:55]
    v_lshlrev_b32 v56, 16, v28
    v_and_b32 v57, 0xffff0000, v28
    v_dot2_f32_bf16 v62, v28, v76, v62
    v_pk_add_f32 v[60:61], v[60:61], v[56:57]
    v_lshlrev_b32 v58, 16, v29
    v_and_b32 v59, 0xffff0000, v29
    v_dot2_f32_bf16 v62, v29, v77, v62
    v_pk_add_f32 v[60:61], v[60:61], v[58:59]
    v_add_f32 v60, v60, v61
    s_nop 1
    v_add_f32_dpp v60, v60, v60 row_ror:8 row_mask:0xf bank_mask:0xf
    s_nop 1
    v_add_f32_dpp v60, v60, v60 row_ror:4 row_mask:0xf bank_mask:0xf
    s_nop 1
    v_add_f32_dpp v60, v60, v60 row_ror:2 row_mask:0xf bank_mask:0xf
    s_nop 1
    v_add_f32_dpp v60, v60, v60 row_ror:1 row_mask:0xf bank_mask:0xf
    s_nop 1
    v_add_f32_dpp v62, v62, v62 row_ror:8 row_mask:0xf bank_mask:0xf
    s_nop 1
    v_add_f32_dpp v62, v62, v62 row_ror:4 row_mask:0xf bank_mask:0xf
    s_nop 1
    v_add_f32_dpp v62, v62, v62 row_ror:2 row_mask:0xf bank_mask:0xf
    s_nop 1
    v_add_f32_dpp v62, v62, v62 row_ror:1 row_mask:0xf bank_mask:0xf
    v_mul_f32 v60, 0x3b124925, v60
    v_mov_b32 v14, 0
    v_mov_b32 v15, 0
    v_pk_add_f32 v[32:33], v[32:33], v[60:61] op_sel_hi:[1,0] neg_lo:[0,1] neg_hi:[0,1]
    v_pk_fma_f32 v[14:15], v[32:33], v[32:33], v[14:15]
    v_pk_add_f32 v[34:35], v[34:35], v[60:61] op_sel_hi:[1,0] neg_lo:[0,1] neg_hi:[0,1]
    v_pk_fma_f32 v[14:15], v[34:35], v[34:35], v[14:15]
    v_pk_add_f32 v[36:37], v[36:37], v[60:61] op_sel_hi:[1,0] neg_lo:[0,1] neg_hi:[0,1]
    v_pk_fma_f32 v[14:15], v[36:37], v[36:37], v[14:15]
    v_pk_add_f32 v[38:39], v[38:39], v[60:61] op_sel_hi:[1,0] neg_lo:[0,1] neg_hi:[0,1]
    v_pk_fma_f32 v[14:15], v[38:39], v[38:39], v[14:15]
    v_pk_add_f32 v[40:41], v[40:41], v[60:61] op_sel_hi:[1,0] neg_lo:[0,1] neg_hi:[0,1]
    v_pk_fma_f32 v[14:15], v[40:41], v[40:41], v[14:15]
    v_pk_add_f32 v[42:43], v[42:43], v[60:61] op_sel_hi:[1,0] neg_lo:[0,1] neg_hi:[0,1]
    v_pk_fma_f32 v[14:15], v[42:43], v[42:43], v[14:15]
    v_pk_add_f32 v[44:45], v[44:45], v[60:61] op_sel_hi:[1,0] neg_lo:[0,1] neg_hi:[0,1]
    v_pk_fma_f32 v[14:15], v[44:45], v[44:45], v[14:15]
    v_pk_add_f32 v[46:47], v[46:47], v[60:61] op_sel_hi:[1,0] neg_lo:[0,1] neg_hi:[0,1]
    v_pk_fma_f32 v[14:15], v[46:47], v[46:47], v[14:15]
    v_pk_add_f32 v[48:49], v[48:49], v[60:61] op_sel_hi:[1,0] neg_lo:[0,1] neg_hi:[0,1]
    v_pk_fma_f32 v[14:15], v[48:49], v[48:49], v[14:15]
    v_pk_add_f32 v[50:51], v[50:51], v[60:61] op_sel_hi:[1,0] neg_lo:[0,1] neg_hi:[0,1]
    v_pk_fma_f32 v[14:15], v[50:51], v[50:51], v[14:15]
    v_pk_add_f32 v[52:53], v[52:53], v[60:61] op_sel_hi:[1,0] neg_lo:[0,1] neg_hi:[0,1]
    v_pk_fma_f32 v[14:15], v[52:53], v[52:53], v[14:15]
    v_pk_add_f32 v[54:55], v[54:55], v[60:61] op_sel_hi:[1,0] neg_lo:[0,1] neg_hi:[0,1]
    v_pk_fma_f32 v[14:15], v[54:55], v[54:55], v[14:15]
    v_pk_add_f32 v[56:57], v[56:57], v[60:61] op_sel_hi:[1,0] neg_lo:[0,1] neg_hi:[0,1]
    v_pk_fma_f32 v[14:15], v[56:57], v[56:57], v[14:15]
    v_pk_add_f32 v[58:59], v[58:59], v[60:61] op_sel_hi:[1,0] neg_lo:[0,1] neg_hi:[0,1]
    v_pk_fma_f32 v[14:15], v[58:59], v[58:59], v[14:15]
    v_add_f32 v14, v14, v15
    s_nop 1
    v_add_f32_dpp v14, v14, v14 row_ror:8 row_mask:0xf bank_mask:0xf
    s_nop 1
    v_add_f32_dpp v14, v14, v14 row_ror:4 row_mask:0xf bank_mask:0xf
    s_nop 1
    v_add_f32_dpp v14, v14, v14 row_ror:2 row_mask:0xf bank_mask:0xf
    s_nop 1
    v_add_f32_dpp v14, v14, v14 row_ror:1 row_mask:0xf bank_mask:0xf
    v_mov_b32 v15, 0x3727c5ac
    v_fmac_f32 v15, 0x3b124925, v14
    v_rsq_f32 v60, v15
    v_mul_f32 v62, 0xbfb8aa3b, v62
    v_exp_f32 v62, v62
    v_mul_u32_u24 v9, 912, v6
    v_add_f32 v62, 1.0, v62
    v_rcp_f32 v62, v62
    v_add_u32 v9, v9, v7
    v_add_u32 v9, 129536, v9
    v_pk_mul_f32 v[32:33], v[32:33], v[60:61] op_sel_hi:[1,0]
    v_cvt_pk_bf16_f32 v16, v32, v33
    v_pk_mul_f32 v[34:35], v[34:35], v[60:61] op_sel_hi:[1,0]
    v_cvt_pk_bf16_f32 v17, v34, v35
    ds_write_b64 v9, v[16:17] offset:0
    v_pk_mul_f32 v[36:37], v[36:37], v[60:61] op_sel_hi:[1,0]
    v_cvt_pk_bf16_f32 v18, v36, v37
    v_pk_mul_f32 v[38:39], v[38:39], v[60:61] op_sel_hi:[1,0]
    v_cvt_pk_bf16_f32 v19, v38, v39
    ds_write_b64 v9, v[18:19] offset:128
    v_pk_mul_f32 v[40:41], v[40:41], v[60:61] op_sel_hi:[1,0]
    v_cvt_pk_bf16_f32 v20, v40, v41
    v_pk_mul_f32 v[42:43], v[42:43], v[60:61] op_sel_hi:[1,0]
    v_cvt_pk_bf16_f32 v21, v42, v43
    ds_write_b64 v9, v[20:21] offset:256
    v_pk_mul_f32 v[44:45], v[44:45], v[60:61] op_sel_hi:[1,0]
    v_cvt_pk_bf16_f32 v22, v44, v45
    v_pk_mul_f32 v[46:47], v[46:47], v[60:61] op_sel_hi:[1,0]
    v_cvt_pk_bf16_f32 v23, v46, v47
    ds_write_b64 v9, v[22:23] offset:384
    v_pk_mul_f32 v[48:49], v[48:49], v[60:61] op_sel_hi:[1,0]
    v_cvt_pk_bf16_f32 v24, v48, v49
    v_pk_mul_f32 v[50:51], v[50:51], v[60:61] op_sel_hi:[1,0]
    v_cvt_pk_bf16_f32 v25, v50, v51
    ds_write_b64 v9, v[24:25] offset:512
    v_pk_mul_f32 v[52:53], v[52:53], v[60:61] op_sel_hi:[1,0]
    v_cvt_pk_bf16_f32 v26, v52, v53
    v_pk_mul_f32 v[54:55], v[54:55], v[60:61] op_sel_hi:[1,0]
    v_cvt_pk_bf16_f32 v27, v54, v55
    ds_write_b64 v9, v[26:27] offset:640
    v_pk_mul_f32 v[56:57], v[56:57], v[60:61] op_sel_hi:[1,0]
    v_cvt_pk_bf16_f32 v28, v56, v57
    v_pk_mul_f32 v[58:59], v[58:59], v[60:61] op_sel_hi:[1,0]
    v_cvt_pk_bf16_f32 v29, v58, v59
    ds_write_b64 v9, v[28:29] offset:768
    s_cbranch_execz K1_BAR1
    v_lshlrev_b32 v6, 2, v6
    s_lshl_b32 s47, s46, 6
    s_add_u32 s47, s47, 4194304
    s_mov_b32 exec_lo, 0x10001
    s_mov_b32 exec_hi, 0x10001
    buffer_store_dword v62, v6, s[36:39], s47 offen
    s_branch K1_BAR1
K1_BAR:
    v_and_b32 v3, 31, v1
    v_mul_u32_u24 v10, 912, v3
    v_lshrrev_b32 v3, 5, v1
    v_lshl_add_u32 v10, v3, 4, v10
    s_mov_b64 exec, 0
    s_cmp_eq_u32 s16, 0
    s_cbranch_scc1 K1_GO
    s_cmp_lt_u32 s18, 2
    s_cbranch_scc1 K1_WKV
    s_cmp_eq_u32 s16, 1
    s_cbranch_scc1 K1_HT
K1_WKV:
    s_cmp_eq_u32 s16, 1
    s_cbranch_scc1 K1_KV
K1_BAR1:
    s_mov_b64 exec, -1
    v_lshrrev_b32 v14, 5, v0
    v_cmp_lt_u32 vcc, 31, v1
    s_waitcnt vmcnt(0) lgkmcnt(0)
    s_barrier
    s_lshr_b32 s52, s2, 6
    s_lshl_b32 s52, s52, 9
    s_and_b32 s53, s2, 56
    s_mul_i32 s53, s53, 3
    s_add_u32 s52, s52, s53
    s_mul_i32 s52, s52, 28
    s_and_b32 s53, s2, 7
    s_mul_i32 s53, s53, 7
    s_lshr_b32 s53, s53, 1
    s_add_u32 s52, s52, s53
    s_lshl_b32 s52, s52, 7
    s_mov_b32 s50, 7340032
    s_mov_b32 s51, 0x20000
    s_mov_b32 s53, 96
    v_lshrrev_b32 v13, 2, v0
    v_mul_u32_u24 v13, 3584, v13
    v_and_b32 v14, 3, v0
    v_lshl_add_u32 v13, v14, 7, v13
    v_cmp_gt_u32 s[54:55], s53, v0
    s_and_saveexec_b64 s[54:55], s[54:55]
    buffer_load_dword v13, v13, s[48:51], s52 offen
    s_mov_b64 exec, -1
    s_cmp_lg_u32 s16, 5
    s_cbranch_scc1 K1_PFD
    s_mov_b32 s78, 401408
    s_mov_b32 s79, 0x20000
    s_mul_i32 s52, s2, 1664
    v_lshlrev_b32 v14, 7, v1
    s_mov_b64 exec, 0x1fff
    buffer_load_dword v14, v14, s[76:79], s52 offen
    s_mov_b64 exec, -1
K1_PFD:
K1_GO:
    s_cmp_ge_u32 s16, 4
    s_cbranch_scc1 K1_EXTRA
    s_mul_i32 s44, s16, 56
    s_add_u32 s44, s44, 29184
    v_lshrrev_b32 v3, 5, v1
    v_lshlrev_b32 v3, 3, v3
    v_bfe_u32 v4, v1, 2, 2
    v_add_u32 v3, v3, v4
    v_mul_u32_u24 v11, 224, v3
    v_bfe_u32 v4, v1, 4, 1
    v_lshl_add_u32 v11, v4, 5, v11
    v_and_b32 v4, 3, v1
    v_lshl_add_u32 v11, v4, 3, v11
    v_add_u32 v11, s44, v11
    v_add_u32 v12, 50176, v11
    ds_read_b128 v[32:35], v10 offset:0
    ds_read_b64_tr_b16 v[36:37], v11 offset:0
    ds_read_b64_tr_b16 v[38:39], v11 offset:896
    ds_read_b128 v[40:43], v10 offset:32
    ds_read_b64_tr_b16 v[44:45], v11 offset:3584
    ds_read_b64_tr_b16 v[46:47], v11 offset:4480
    ds_read_b128 v[48:51], v10 offset:64
    ds_read_b64_tr_b16 v[52:53], v11 offset:7168
    ds_read_b64_tr_b16 v[54:55], v11 offset:8064
    ds_read_b128 v[56:59], v10 offset:96
    ds_read_b64_tr_b16 v[60:61], v11 offset:10752
    ds_read_b64_tr_b16 v[62:63], v11 offset:11648
    s_waitcnt lgkmcnt(9)
    v_mfma_f32_32x32x16_bf16 v[16:31], v[36:39], v[32:35], 0
    ds_read_b128 v[32:35], v10 offset:128
    ds_read_b64_tr_b16 v[36:37], v11 offset:14336
    ds_read_b64_tr_b16 v[38:39], v11 offset:15232
    s_waitcnt lgkmcnt(9)
    v_mfma_f32_32x32x16_bf16 v[16:31], v[44:47], v[40:43], v[16:31]
    ds_read_b128 v[40:43], v10 offset:160
    ds_read_b64_tr_b16 v[44:45], v11 offset:17920
    ds_read_b64_tr_b16 v[46:47], v11 offset:18816
    s_waitcnt lgkmcnt(9)
    v_mfma_f32_32x32x16_bf16 v[16:31], v[52:55], v[48:51], v[16:31]
    ds_read_b128 v[48:51], v10 offset:192
    ds_read_b64_tr_b16 v[52:53], v11 offset:21504
    ds_read_b64_tr_b16 v[54:55], v11 offset:22400
    s_waitcnt lgkmcnt(9)
    v_mfma_f32_32x32x16_bf16 v[16:31], v[60:63], v[56:59], v[16:31]
    ds_read_b128 v[56:59], v10 offset:224
    ds_read_b64_tr_b16 v[60:61], v11 offset:25088
    ds_read_b64_tr_b16 v[62:63], v11 offset:25984
    s_waitcnt lgkmcnt(9)
    v_mfma_f32_32x32x16_bf16 v[16:31], v[36:39], v[32:35], v[16:31]
    ds_read_b128 v[32:35], v10 offset:256
    ds_read_b64_tr_b16 v[36:37], v11 offset:28672
    ds_read_b64_tr_b16 v[38:39], v11 offset:29568
    s_waitcnt lgkmcnt(9)
    v_mfma_f32_32x32x16_bf16 v[16:31], v[44:47], v[40:43], v[16:31]
    ds_read_b128 v[40:43], v10 offset:288
    ds_read_b64_tr_b16 v[44:45], v11 offset:32256
    ds_read_b64_tr_b16 v[46:47], v11 offset:33152
    s_waitcnt lgkmcnt(9)
    v_mfma_f32_32x32x16_bf16 v[16:31], v[52:55], v[48:51], v[16:31]
    ds_read_b128 v[48:51], v10 offset:320
    ds_read_b64_tr_b16 v[52:53], v11 offset:35840
    ds_read_b64_tr_b16 v[54:55], v11 offset:36736
    s_waitcnt lgkmcnt(9)
    v_mfma_f32_32x32x16_bf16 v[16:31], v[60:63], v[56:59], v[16:31]
    ds_read_b128 v[56:59], v10 offset:352
    ds_read_b64_tr_b16 v[60:61], v11 offset:39424
    ds_read_b64_tr_b16 v[62:63], v11 offset:40320
    s_waitcnt lgkmcnt(9)
    v_mfma_f32_32x32x16_bf16 v[16:31], v[36:39], v[32:35], v[16:31]
    ds_read_b128 v[32:35], v10 offset:384
    ds_read_b64_tr_b16 v[36:37], v11 offset:43008
    ds_read_b64_tr_b16 v[38:39], v11 offset:43904
    s_waitcnt lgkmcnt(9)
    v_mfma_f32_32x32x16_bf16 v[16:31], v[44:47], v[40:43], v[16:31]
    ds_read_b128 v[40:43], v10 offset:416
    ds_read_b64_tr_b16 v[44:45], v11 offset:46592
    ds_read_b64_tr_b16 v[46:47], v11 offset:47488
    s_waitcnt lgkmcnt(9)
    v_mfma_f32_32x32x16_bf16 v[16:31], v[52:55], v[48:51], v[16:31]
    ds_read_b128 v[48:51], v10 offset:448
    ds_read_b64_tr_b16 v[52:53], v12 offset:0
    ds_read_b64_tr_b16 v[54:55], v12 offset:896
    s_waitcnt lgkmcnt(9)
    v_mfma_f32_32x32x16_bf16 v[16:31], v[60:63], v[56:59], v[16:31]
    ds_read_b128 v[56:59], v10 offset:480
    ds_read_b64_tr_b16 v[60:61], v12 offset:3584
    ds_read_b64_tr_b16 v[62:63], v12 offset:4480
    s_waitcnt lgkmcnt(9)
    v_mfma_f32_32x32x16_bf16 v[16:31], v[36:39], v[32:35], v[16:31]
    ds_read_b128 v[32:35], v10 offset:512
    ds_read_b64_tr_b16 v[36:37], v12 offset:7168
    ds_read_b64_tr_b16 v[38:39], v12 offset:8064
    s_waitcnt lgkmcnt(9)
    v_mfma_f32_32x32x16_bf16 v[16:31], v[44:47], v[40:43], v[16:31]
    ds_read_b128 v[40:43], v10 offset:544
    ds_read_b64_tr_b16 v[44:45], v12 offset:10752
    ds_read_b64_tr_b16 v[46:47], v12 offset:11648
    s_waitcnt lgkmcnt(9)
    v_mfma_f32_32x32x16_bf16 v[16:31], v[52:55], v[48:51], v[16:31]
    ds_read_b128 v[48:51], v10 offset:576
    ds_read_b64_tr_b16 v[52:53], v12 offset:14336
    ds_read_b64_tr_b16 v[54:55], v12 offset:15232
    s_waitcnt lgkmcnt(9)
    v_mfma_f32_32x32x16_bf16 v[16:31], v[60:63], v[56:59], v[16:31]
    ds_read_b128 v[56:59], v10 offset:608
    ds_read_b64_tr_b16 v[60:61], v12 offset:17920
    ds_read_b64_tr_b16 v[62:63], v12 offset:18816
    s_waitcnt lgkmcnt(9)
    v_mfma_f32_32x32x16_bf16 v[16:31], v[36:39], v[32:35], v[16:31]
    ds_read_b128 v[32:35], v10 offset:640
    ds_read_b64_tr_b16 v[36:37], v12 offset:21504
    ds_read_b64_tr_b16 v[38:39], v12 offset:22400
    s_waitcnt lgkmcnt(9)
    v_mfma_f32_32x32x16_bf16 v[16:31], v[44:47], v[40:43], v[16:31]
    ds_read_b128 v[40:43], v10 offset:672
    ds_read_b64_tr_b16 v[44:45], v12 offset:25088
    ds_read_b64_tr_b16 v[46:47], v12 offset:25984
    s_waitcnt lgkmcnt(9)
    v_mfma_f32_32x32x16_bf16 v[16:31], v[52:55], v[48:51], v[16:31]
    ds_read_b128 v[48:51], v10 offset:704
    ds_read_b64_tr_b16 v[52:53], v12 offset:28672
    ds_read_b64_tr_b16 v[54:55], v12 offset:29568
    s_waitcnt lgkmcnt(9)
    v_mfma_f32_32x32x16_bf16 v[16:31], v[60:63], v[56:59], v[16:31]
    ds_read_b128 v[56:59], v10 offset:736
    ds_read_b64_tr_b16 v[60:61], v12 offset:32256
    ds_read_b64_tr_b16 v[62:63], v12 offset:33152
    s_waitcnt lgkmcnt(9)
    v_mfma_f32_32x32x16_bf16 v[16:31], v[36:39], v[32:35], v[16:31]
    ds_read_b128 v[32:35], v10 offset:768
    ds_read_b64_tr_b16 v[36:37], v12 offset:35840
    ds_read_b64_tr_b16 v[38:39], v12 offset:36736
    s_waitcnt lgkmcnt(9)
    v_mfma_f32_32x32x16_bf16 v[16:31], v[44:47], v[40:43], v[16:31]
    ds_read_b128 v[40:43], v10 offset:800
    ds_read_b64_tr_b16 v[44:45], v12 offset:39424
    ds_read_b64_tr_b16 v[46:47], v12 offset:40320
    s_waitcnt lgkmcnt(9)
    v_mfma_f32_32x32x16_bf16 v[16:31], v[52:55], v[48:51], v[16:31]
    ds_read_b128 v[48:51], v10 offset:832
    ds_read_b64_tr_b16 v[52:53], v12 offset:43008
    ds_read_b64_tr_b16 v[54:55], v12 offset:43904
    s_waitcnt lgkmcnt(9)
    v_mfma_f32_32x32x16_bf16 v[16:31], v[60:63], v[56:59], v[16:31]
    ds_read_b128 v[56:59], v10 offset:864
    ds_read_b64_tr_b16 v[60:61], v12 offset:46592
    ds_read_b64_tr_b16 v[62:63], v12 offset:47488
    s_waitcnt lgkmcnt(9)
    v_mfma_f32_32x32x16_bf16 v[16:31], v[36:39], v[32:35], v[16:31]
    s_waitcnt lgkmcnt(6)
    v_mfma_f32_32x32x16_bf16 v[16:31], v[44:47], v[40:43], v[16:31]
    s_waitcnt lgkmcnt(3)
    v_mfma_f32_32x32x16_bf16 v[16:31], v[52:55], v[48:51], v[16:31]
    s_waitcnt lgkmcnt(0)
    v_mfma_f32_32x32x16_bf16 v[16:31], v[60:63], v[56:59], v[16:31]
    s_nop 7
    s_nop 4
    s_mov_b32 s44, 0x3e8b97f6
    v_mul_f32 v16, s44, v16
    v_mul_f32 v17, s44, v17
    v_mul_f32 v18, s44, v18
    v_mul_f32 v19, s44, v19
    v_mul_f32 v20, s44, v20
    v_mul_f32 v21, s44, v21
    v_mul_f32 v22, s44, v22
    v_mul_f32 v23, s44, v23
    v_mul_f32 v24, s44, v24
    v_mul_f32 v25, s44, v25
    v_mul_f32 v26, s44, v26
    v_mul_f32 v27, s44, v27
    v_mul_f32 v28, s44, v28
    v_mul_f32 v29, s44, v29
    v_mul_f32 v30, s44, v30
    v_mul_f32 v31, s44, v31
    v_cvt_pk_bf16_f32 v32, v16, v17
    v_cvt_pk_bf16_f32 v33, v18, v19
    v_cvt_pk_bf16_f32 v34, v20, v21
    v_cvt_pk_bf16_f32 v35, v22, v23
    v_cvt_pk_bf16_f32 v36, v24, v25
    v_cvt_pk_bf16_f32 v37, v26, v27
    v_cvt_pk_bf16_f32 v38, v28, v29
    v_cvt_pk_bf16_f32 v39, v30, v31
    v_cndmask_b32 v38, v38, 0, vcc
    v_cndmask_b32 v39, v39, 0, vcc
    s_lshl_b32 s44, s17, 2
    s_add_u32 s44, s44, s18
    s_lshl_b32 s44, s44, 2
    s_add_u32 s44, s44, s16
    s_lshl_b32 s44, s44, 11
    s_branch K1_ST2
K1_EXTRA:
    s_cmp_ge_u32 s18, 2
    s_cbranch_scc1 K1_HT
    s_cmp_lg_u32 s16, 4
    s_cbranch_scc1 K1_FIN
K1_KV:
    s_mov_b32 s44, 129536
    v_lshrrev_b32 v3, 5, v1
    v_lshlrev_b32 v3, 3, v3
    v_bfe_u32 v4, v1, 2, 2
    v_add_u32 v3, v3, v4
    v_mul_u32_u24 v11, 56, v3
    v_bfe_u32 v4, v1, 4, 1
    v_lshl_add_u32 v11, v4, 5, v11
    v_and_b32 v4, 3, v1
    v_lshl_add_u32 v11, v4, 3, v11
    v_add_u32 v11, s44, v11
    v_add_u32 v12, 12544, v11
    s_cmp_eq_u32 s18, 1
    s_cbranch_scc1 K1_V
    ds_read_b128 v[32:35], v10 offset:0
    ds_read_b64_tr_b16 v[36:37], v11 offset:0
    ds_read_b64_tr_b16 v[38:39], v11 offset:224
    ds_read_b128 v[40:43], v10 offset:32
    ds_read_b64_tr_b16 v[44:45], v11 offset:896
    ds_read_b64_tr_b16 v[46:47], v11 offset:1120
    ds_read_b128 v[48:51], v10 offset:64
    ds_read_b64_tr_b16 v[52:53], v11 offset:1792
    ds_read_b64_tr_b16 v[54:55], v11 offset:2016
    ds_read_b128 v[56:59], v10 offset:96
    ds_read_b64_tr_b16 v[60:61], v11 offset:2688
    ds_read_b64_tr_b16 v[62:63], v11 offset:2912
    s_waitcnt lgkmcnt(9)
    v_mfma_f32_32x32x16_bf16 v[16:31], v[36:39], v[32:35], 0
    ds_read_b128 v[32:35], v10 offset:128
    ds_read_b64_tr_b16 v[36:37], v11 offset:3584
    ds_read_b64_tr_b16 v[38:39], v11 offset:3808
    s_waitcnt lgkmcnt(9)
    v_mfma_f32_32x32x16_bf16 v[16:31], v[44:47], v[40:43], v[16:31]
    ds_read_b128 v[40:43], v10 offset:160
    ds_read_b64_tr_b16 v[44:45], v11 offset:4480
    ds_read_b64_tr_b16 v[46:47], v11 offset:4704
    s_waitcnt lgkmcnt(9)
    v_mfma_f32_32x32x16_bf16 v[16:31], v[52:55], v[48:51], v[16:31]
    ds_read_b128 v[48:51], v10 offset:192
    ds_read_b64_tr_b16 v[52:53], v11 offset:5376
    ds_read_b64_tr_b16 v[54:55], v11 offset:5600
    s_waitcnt lgkmcnt(9)
    v_mfma_f32_32x32x16_bf16 v[16:31], v[60:63], v[56:59], v[16:31]
    ds_read_b128 v[56:59], v10 offset:224
    ds_read_b64_tr_b16 v[60:61], v11 offset:6272
    ds_read_b64_tr_b16 v[62:63], v11 offset:6496
    s_waitcnt lgkmcnt(9)
    v_mfma_f32_32x32x16_bf16 v[16:31], v[36:39], v[32:35], v[16:31]
    ds_read_b128 v[32:35], v10 offset:256
    ds_read_b64_tr_b16 v[36:37], v11 offset:7168
    ds_read_b64_tr_b16 v[38:39], v11 offset:7392
    s_waitcnt lgkmcnt(9)
    v_mfma_f32_32x32x16_bf16 v[16:31], v[44:47], v[40:43], v[16:31]
    ds_read_b128 v[40:43], v10 offset:288
    ds_read_b64_tr_b16 v[44:45], v11 offset:8064
    ds_read_b64_tr_b16 v[46:47], v11 offset:8288
    s_waitcnt lgkmcnt(9)
    v_mfma_f32_32x32x16_bf16 v[16:31], v[52:55], v[48:51], v[16:31]
    ds_read_b128 v[48:51], v10 offset:320
    ds_read_b64_tr_b16 v[52:53], v11 offset:8960
    ds_read_b64_tr_b16 v[54:55], v11 offset:9184
    s_waitcnt lgkmcnt(9)
    v_mfma_f32_32x32x16_bf16 v[16:31], v[60:63], v[56:59], v[16:31]
    ds_read_b128 v[56:59], v10 offset:352
    ds_read_b64_tr_b16 v[60:61], v11 offset:9856
    ds_read_b64_tr_b16 v[62:63], v11 offset:10080
    s_waitcnt lgkmcnt(9)
    v_mfma_f32_32x32x16_bf16 v[16:31], v[36:39], v[32:35], v[16:31]
    ds_read_b128 v[32:35], v10 offset:384
    ds_read_b64_tr_b16 v[36:37], v11 offset:10752
    ds_read_b64_tr_b16 v[38:39], v11 offset:10976
    s_waitcnt lgkmcnt(9)
    v_mfma_f32_32x32x16_bf16 v[16:31], v[44:47], v[40:43], v[16:31]
    ds_read_b128 v[40:43], v10 offset:416
    ds_read_b64_tr_b16 v[44:45], v11 offset:11648
    ds_read_b64_tr_b16 v[46:47], v11 offset:11872
    s_waitcnt lgkmcnt(9)
    v_mfma_f32_32x32x16_bf16 v[16:31], v[52:55], v[48:51], v[16:31]
    ds_read_b128 v[48:51], v10 offset:448
    ds_read_b64_tr_b16 v[52:53], v12 offset:0
    ds_read_b64_tr_b16 v[54:55], v12 offset:224
    s_waitcnt lgkmcnt(9)
    v_mfma_f32_32x32x16_bf16 v[16:31], v[60:63], v[56:59], v[16:31]
    ds_read_b128 v[56:59], v10 offset:480
    ds_read_b64_tr_b16 v[60:61], v12 offset:896
    ds_read_b64_tr_b16 v[62:63], v12 offset:1120
    s_waitcnt lgkmcnt(9)
    v_mfma_f32_32x32x16_bf16 v[16:31], v[36:39], v[32:35], v[16:31]
    ds_read_b128 v[32:35], v10 offset:512
    ds_read_b64_tr_b16 v[36:37], v12 offset:1792
    ds_read_b64_tr_b16 v[38:39], v12 offset:2016
    s_waitcnt lgkmcnt(9)
    v_mfma_f32_32x32x16_bf16 v[16:31], v[44:47], v[40:43], v[16:31]
    ds_read_b128 v[40:43], v10 offset:544
    ds_read_b64_tr_b16 v[44:45], v12 offset:2688
    ds_read_b64_tr_b16 v[46:47], v12 offset:2912
    s_waitcnt lgkmcnt(9)
    v_mfma_f32_32x32x16_bf16 v[16:31], v[52:55], v[48:51], v[16:31]
    ds_read_b128 v[48:51], v10 offset:576
    ds_read_b64_tr_b16 v[52:53], v12 offset:3584
    ds_read_b64_tr_b16 v[54:55], v12 offset:3808
    s_waitcnt lgkmcnt(9)
    v_mfma_f32_32x32x16_bf16 v[16:31], v[60:63], v[56:59], v[16:31]
    ds_read_b128 v[56:59], v10 offset:608
    ds_read_b64_tr_b16 v[60:61], v12 offset:4480
    ds_read_b64_tr_b16 v[62:63], v12 offset:4704
    s_waitcnt lgkmcnt(9)
    v_mfma_f32_32x32x16_bf16 v[16:31], v[36:39], v[32:35], v[16:31]
    ds_read_b128 v[32:35], v10 offset:640
    ds_read_b64_tr_b16 v[36:37], v12 offset:5376
    ds_read_b64_tr_b16 v[38:39], v12 offset:5600
    s_waitcnt lgkmcnt(9)
    v_mfma_f32_32x32x16_bf16 v[16:31], v[44:47], v[40:43], v[16:31]
    ds_read_b128 v[40:43], v10 offset:672
    ds_read_b64_tr_b16 v[44:45], v12 offset:6272
    ds_read_b64_tr_b16 v[46:47], v12 offset:6496
    s_waitcnt lgkmcnt(9)
    v_mfma_f32_32x32x16_bf16 v[16:31], v[52:55], v[48:51], v[16:31]
    ds_read_b128 v[48:51], v10 offset:704
    ds_read_b64_tr_b16 v[52:53], v12 offset:7168
    ds_read_b64_tr_b16 v[54:55], v12 offset:7392
    s_waitcnt lgkmcnt(9)
    v_mfma_f32_32x32x16_bf16 v[16:31], v[60:63], v[56:59], v[16:31]
    ds_read_b128 v[56:59], v10 offset:736
    ds_read_b64_tr_b16 v[60:61], v12 offset:8064
    ds_read_b64_tr_b16 v[62:63], v12 offset:8288
    s_waitcnt lgkmcnt(9)
    v_mfma_f32_32x32x16_bf16 v[16:31], v[36:39], v[32:35], v[16:31]
    ds_read_b128 v[32:35], v10 offset:768
    ds_read_b64_tr_b16 v[36:37], v12 offset:8960
    ds_read_b64_tr_b16 v[38:39], v12 offset:9184
    s_waitcnt lgkmcnt(9)
    v_mfma_f32_32x32x16_bf16 v[16:31], v[44:47], v[40:43], v[16:31]
    ds_read_b128 v[40:43], v10 offset:800
    ds_read_b64_tr_b16 v[44:45], v12 offset:9856
    ds_read_b64_tr_b16 v[46:47], v12 offset:10080
    s_waitcnt lgkmcnt(9)
    v_mfma_f32_32x32x16_bf16 v[16:31], v[52:55], v[48:51], v[16:31]
    ds_read_b128 v[48:51], v10 offset:832
    ds_read_b64_tr_b16 v[52:53], v12 offset:10752
    ds_read_b64_tr_b16 v[54:55], v12 offset:10976
    s_waitcnt lgkmcnt(9)
    v_mfma_f32_32x32x16_bf16 v[16:31], v[60:63], v[56:59], v[16:31]
    ds_read_b128 v[56:59], v10 offset:864
    ds_read_b64_tr_b16 v[60:61], v12 offset:11648
    ds_read_b64_tr_b16 v[62:63], v12 offset:11872
    s_waitcnt lgkmcnt(9)
    v_mfma_f32_32x32x16_bf16 v[16:31], v[36:39], v[32:35], v[16:31]
    s_waitcnt lgkmcnt(6)
    v_mfma_f32_32x32x16_bf16 v[16:31], v[44:47], v[40:43], v[16:31]
    s_waitcnt lgkmcnt(3)
    v_mfma_f32_32x32x16_bf16 v[16:31], v[52:55], v[48:51], v[16:31]
    s_waitcnt lgkmcnt(0)
    v_mfma_f32_32x32x16_bf16 v[16:31], v[60:63], v[56:59], v[16:31]
    s_nop 7
    s_nop 4
    v_cvt_pk_bf16_f32 v32, v16, v17
    v_cvt_pk_bf16_f32 v33, v18, v19
    v_cvt_pk_bf16_f32 v34, v20, v21
    v_cvt_pk_bf16_f32 v35, v22, v23
    v_cvt_pk_bf16_f32 v36, v24, v25
    v_cvt_pk_bf16_f32 v37, v26, v27
    v_cvt_pk_bf16_f32 v38, v28, v29
    v_cvt_pk_bf16_f32 v39, v30, v31
    v_mov_b32 v3, 0x3f803f80
    v_mov_b32 v4, 0x3f80
    v_cndmask_b32 v38, v38, v3, vcc
    v_cndmask_b32 v39, v39, v4, vcc
    s_lshl_b32 s44, s17, 12
    s_add_u32 s44, s44, 2097152
    s_branch K1_ST2
K1_V:
    ds_read_b128 v[32:35], v10 offset:0
    ds_read_b64_tr_b16 v[36:37], v11 offset:0
    ds_read_b64_tr_b16 v[38:39], v11 offset:224
    ds_read_b128 v[40:43], v10 offset:32
    ds_read_b64_tr_b16 v[44:45], v11 offset:896
    ds_read_b64_tr_b16 v[46:47], v11 offset:1120
    ds_read_b128 v[48:51], v10 offset:64
    ds_read_b64_tr_b16 v[52:53], v11 offset:1792
    ds_read_b64_tr_b16 v[54:55], v11 offset:2016
    ds_read_b128 v[56:59], v10 offset:96
    ds_read_b64_tr_b16 v[60:61], v11 offset:2688
    ds_read_b64_tr_b16 v[62:63], v11 offset:2912
    s_waitcnt lgkmcnt(9)
    v_mfma_f32_32x32x16_bf16 v[16:31], v[32:35], v[36:39], 0
    ds_read_b128 v[32:35], v10 offset:128
    ds_read_b64_tr_b16 v[36:37], v11 offset:3584
    ds_read_b64_tr_b16 v[38:39], v11 offset:3808
    s_waitcnt lgkmcnt(9)
    v_mfma_f32_32x32x16_bf16 v[16:31], v[40:43], v[44:47], v[16:31]
    ds_read_b128 v[40:43], v10 offset:160
    ds_read_b64_tr_b16 v[44:45], v11 offset:4480
    ds_read_b64_tr_b16 v[46:47], v11 offset:4704
    s_waitcnt lgkmcnt(9)
    v_mfma_f32_32x32x16_bf16 v[16:31], v[48:51], v[52:55], v[16:31]
    ds_read_b128 v[48:51], v10 offset:192
    ds_read_b64_tr_b16 v[52:53], v11 offset:5376
    ds_read_b64_tr_b16 v[54:55], v11 offset:5600
    s_waitcnt lgkmcnt(9)
    v_mfma_f32_32x32x16_bf16 v[16:31], v[56:59], v[60:63], v[16:31]
    ds_read_b128 v[56:59], v10 offset:224
    ds_read_b64_tr_b16 v[60:61], v11 offset:6272
    ds_read_b64_tr_b16 v[62:63], v11 offset:6496
    s_waitcnt lgkmcnt(9)
    v_mfma_f32_32x32x16_bf16 v[16:31], v[32:35], v[36:39], v[16:31]
    ds_read_b128 v[32:35], v10 offset:256
    ds_read_b64_tr_b16 v[36:37], v11 offset:7168
    ds_read_b64_tr_b16 v[38:39], v11 offset:7392
    s_waitcnt lgkmcnt(9)
    v_mfma_f32_32x32x16_bf16 v[16:31], v[40:43], v[44:47], v[16:31]
    ds_read_b128 v[40:43], v10 offset:288
    ds_read_b64_tr_b16 v[44:45], v11 offset:8064
    ds_read_b64_tr_b16 v[46:47], v11 offset:8288
    s_waitcnt lgkmcnt(9)
    v_mfma_f32_32x32x16_bf16 v[16:31], v[48:51], v[52:55], v[16:31]
    ds_read_b128 v[48:51], v10 offset:320
    ds_read_b64_tr_b16 v[52:53], v11 offset:8960
    ds_read_b64_tr_b16 v[54:55], v11 offset:9184
    s_waitcnt lgkmcnt(9)
    v_mfma_f32_32x32x16_bf16 v[16:31], v[56:59], v[60:63], v[16:31]
    ds_read_b128 v[56:59], v10 offset:352
    ds_read_b64_tr_b16 v[60:61], v11 offset:9856
    ds_read_b64_tr_b16 v[62:63], v11 offset:10080
    s_waitcnt lgkmcnt(9)
    v_mfma_f32_32x32x16_bf16 v[16:31], v[32:35], v[36:39], v[16:31]
    ds_read_b128 v[32:35], v10 offset:384
    ds_read_b64_tr_b16 v[36:37], v11 offset:10752
    ds_read_b64_tr_b16 v[38:39], v11 offset:10976
    s_waitcnt lgkmcnt(9)
    v_mfma_f32_32x32x16_bf16 v[16:31], v[40:43], v[44:47], v[16:31]
    ds_read_b128 v[40:43], v10 offset:416
    ds_read_b64_tr_b16 v[44:45], v11 offset:11648
    ds_read_b64_tr_b16 v[46:47], v11 offset:11872
    s_waitcnt lgkmcnt(9)
    v_mfma_f32_32x32x16_bf16 v[16:31], v[48:51], v[52:55], v[16:31]
    ds_read_b128 v[48:51], v10 offset:448
    ds_read_b64_tr_b16 v[52:53], v12 offset:0
    ds_read_b64_tr_b16 v[54:55], v12 offset:224
    s_waitcnt lgkmcnt(9)
    v_mfma_f32_32x32x16_bf16 v[16:31], v[56:59], v[60:63], v[16:31]
    ds_read_b128 v[56:59], v10 offset:480
    ds_read_b64_tr_b16 v[60:61], v12 offset:896
    ds_read_b64_tr_b16 v[62:63], v12 offset:1120
    s_waitcnt lgkmcnt(9)
    v_mfma_f32_32x32x16_bf16 v[16:31], v[32:35], v[36:39], v[16:31]
    ds_read_b128 v[32:35], v10 offset:512
    ds_read_b64_tr_b16 v[36:37], v12 offset:1792
    ds_read_b64_tr_b16 v[38:39], v12 offset:2016
    s_waitcnt lgkmcnt(9)
    v_mfma_f32_32x32x16_bf16 v[16:31], v[40:43], v[44:47], v[16:31]
    ds_read_b128 v[40:43], v10 offset:544
    ds_read_b64_tr_b16 v[44:45], v12 offset:2688
    ds_read_b64_tr_b16 v[46:47], v12 offset:2912
    s_waitcnt lgkmcnt(9)
    v_mfma_f32_32x32x16_bf16 v[16:31], v[48:51], v[52:55], v[16:31]
    ds_read_b128 v[48:51], v10 offset:576
    ds_read_b64_tr_b16 v[52:53], v12 offset:3584
    ds_read_b64_tr_b16 v[54:55], v12 offset:3808
    s_waitcnt lgkmcnt(9)
    v_mfma_f32_32x32x16_bf16 v[16:31], v[56:59], v[60:63], v[16:31]
    ds_read_b128 v[56:59], v10 offset:608
    ds_read_b64_tr_b16 v[60:61], v12 offset:4480
    ds_read_b64_tr_b16 v[62:63], v12 offset:4704
    s_waitcnt lgkmcnt(9)
    v_mfma_f32_32x32x16_bf16 v[16:31], v[32:35], v[36:39], v[16:31]
    ds_read_b128 v[32:35], v10 offset:640
    ds_read_b64_tr_b16 v[36:37], v12 offset:5376
    ds_read_b64_tr_b16 v[38:39], v12 offset:5600
    s_waitcnt lgkmcnt(9)
    v_mfma_f32_32x32x16_bf16 v[16:31], v[40:43], v[44:47], v[16:31]
    ds_read_b128 v[40:43], v10 offset:672
    ds_read_b64_tr_b16 v[44:45], v12 offset:6272
    ds_read_b64_tr_b16 v[46:47], v12 offset:6496
    s_waitcnt lgkmcnt(9)
    v_mfma_f32_32x32x16_bf16 v[16:31], v[48:51], v[52:55], v[16:31]
    ds_read_b128 v[48:51], v10 offset:704
    ds_read_b64_tr_b16 v[52:53], v12 offset:7168
    ds_read_b64_tr_b16 v[54:55], v12 offset:7392
    s_waitcnt lgkmcnt(9)
    v_mfma_f32_32x32x16_bf16 v[16:31], v[56:59], v[60:63], v[16:31]
    ds_read_b128 v[56:59], v10 offset:736
    ds_read_b64_tr_b16 v[60:61], v12 offset:8064
    ds_read_b64_tr_b16 v[62:63], v12 offset:8288
    s_waitcnt lgkmcnt(9)
    v_mfma_f32_32x32x16_bf16 v[16:31], v[32:35], v[36:39], v[16:31]
    ds_read_b128 v[32:35], v10 offset:768
    ds_read_b64_tr_b16 v[36:37], v12 offset:8960
    ds_read_b64_tr_b16 v[38:39], v12 offset:9184
    s_waitcnt lgkmcnt(9)
    v_mfma_f32_32x32x16_bf16 v[16:31], v[40:43], v[44:47], v[16:31]
    ds_read_b128 v[40:43], v10 offset:800
    ds_read_b64_tr_b16 v[44:45], v12 offset:9856
    ds_read_b64_tr_b16 v[46:47], v12 offset:10080
    s_waitcnt lgkmcnt(9)
    v_mfma_f32_32x32x16_bf16 v[16:31], v[48:51], v[52:55], v[16:31]
    ds_read_b128 v[48:51], v10 offset:832
    ds_read_b64_tr_b16 v[52:53], v12 offset:10752
    ds_read_b64_tr_b16 v[54:55], v12 offset:10976
    s_waitcnt lgkmcnt(9)
    v_mfma_f32_32x32x16_bf16 v[16:31], v[56:59], v[60:63], v[16:31]
    ds_read_b128 v[56:59], v10 offset:864
    ds_read_b64_tr_b16 v[60:61], v12 offset:11648
    ds_read_b64_tr_b16 v[62:63], v12 offset:11872
    s_waitcnt lgkmcnt(9)
    v_mfma_f32_32x32x16_bf16 v[16:31], v[32:35], v[36:39], v[16:31]
    s_waitcnt lgkmcnt(6)
    v_mfma_f32_32x32x16_bf16 v[16:31], v[40:43], v[44:47], v[16:31]
    s_waitcnt lgkmcnt(3)
    v_mfma_f32_32x32x16_bf16 v[16:31], v[48:51], v[52:55], v[16:31]
    s_waitcnt lgkmcnt(0)
    v_mfma_f32_32x32x16_bf16 v[16:31], v[56:59], v[60:63], v[16:31]
    s_nop 7
    s_nop 4
    v_cvt_pk_bf16_f32 v32, v16, v17
    v_cvt_pk_bf16_f32 v33, v18, v19
    v_cvt_pk_bf16_f32 v34, v20, v21
    v_cvt_pk_bf16_f32 v35, v22, v23
    v_cvt_pk_bf16_f32 v36, v24, v25
    v_cvt_pk_bf16_f32 v37, v26, v27
    v_cvt_pk_bf16_f32 v38, v28, v29
    v_cvt_pk_bf16_f32 v39, v30, v31
    v_and_b32 v4, 31, v1
    v_cmp_eq_u32 vcc, 28, v4
    v_mov_b32 v3, 0x3f803f80
    s_nop 0
    v_cndmask_b32 v3, 0, v3, vcc
    v_cmp_lt_u32 vcc, 27, v4
    s_nop 1
    v_cndmask_b32 v32, v32, v3, vcc
    v_cndmask_b32 v33, v33, v3, vcc
    v_cndmask_b32 v34, v34, v3, vcc
    v_cndmask_b32 v35, v35, v3, vcc
    v_cndmask_b32 v36, v36, v3, vcc
    v_cndmask_b32 v37, v37, v3, vcc
    v_cndmask_b32 v38, v38, v3, vcc
    v_cndmask_b32 v39, v39, v3, vcc
    s_lshl_b32 s44, s17, 12
    s_add_u32 s44, s44, 2099200
K1_ST2:
    buffer_store_dwordx4 v[32:35], v2, s[36:39], s44 offen
    buffer_store_dwordx4 v[36:39], v2, s[36:39], s44 offen offset:1024
    s_branch K1_FIN
K1_HT:
    v_lshrrev_b32 v3, 5, v1
    v_lshlrev_b32 v3, 2, v3
    v_bfe_u32 v4, v1, 2, 2
    v_add_u32 v3, v3, v4
    v_mul_u32_u24 v11, 912, v3
    v_bfe_u32 v4, v1, 4, 1
    v_lshl_add_u32 v11, v4, 5, v11
    v_and_b32 v4, 3, v1
    v_lshl_add_u32 v11, v4, 3, v11
    s_sub_u32 s45, s16, 4
    s_lshl_b32 s44, s45, 6
    s_add_u32 s44, s44, 129536
    v_add_u32 v11, s44, v11
    s_lshl_b32 s46, s17, 1
    s_add_u32 s46, s46, s18
    s_sub_u32 s46, s46, 2
    s_lshl_b32 s46, s46, 11
    s_lshr_b32 s44, s45, 1
    s_lshl_b32 s44, s44, 18
    s_add_u32 s46, s46, s44
    s_and_b32 s44, s45, 1
    s_lshl_b32 s44, s44, 10
    s_add_u32 s46, s46, s44
    s_add_u32 s46, s46, 2359296
    ds_read_b64_tr_b16 v[32:33], v11 offset:0
    ds_read_b64_tr_b16 v[34:35], v11 offset:7296
    ds_read_b64_tr_b16 v[36:37], v11 offset:256
    ds_read_b64_tr_b16 v[38:39], v11 offset:7552
    ds_read_b64_tr_b16 v[40:41], v11 offset:512
    ds_read_b64_tr_b16 v[42:43], v11 offset:7808
    ds_read_b64_tr_b16 v[44:45], v11 offset:768
    ds_read_b64_tr_b16 v[46:47], v11 offset:8064
    s_waitcnt lgkmcnt(6)
    buffer_store_dwordx4 v[32:35], v2, s[36:39], s46 offen
    s_add_u32 s46, s46, 524288
    s_waitcnt lgkmcnt(4)
    buffer_store_dwordx4 v[36:39], v2, s[36:39], s46 offen
    s_add_u32 s46, s46, 524288
    s_waitcnt lgkmcnt(2)
    buffer_store_dwordx4 v[40:43], v2, s[36:39], s46 offen
    s_add_u32 s46, s46, 524288
    s_cmp_ge_u32 s45, 2
    s_cbranch_scc1 K1_FIN
    s_waitcnt lgkmcnt(0)
    buffer_store_dwordx4 v[44:47], v2, s[36:39], s46 offen
    s_add_u32 s46, s46, 524288
K1_FIN:
    s_cbranch_execz K1_BAR1
K1_END:
    s_endpgm
    .globl k2_kernel
    .p2align 8
    .type k2_kernel,@function
k2_kernel:
    s_cmp_ge_u32 s2, 256
    s_cbranch_scc1 K2_END
    s_load_dwordx2 s[14:15], s[0:1], 104
    s_load_dwordx8 s[4:11], s[0:1], 48
    s_load_dwordx2 s[12:13], s[0:1], 32
    s_load_dwordx2 s[28:29], s[0:1], 88
    v_lshrrev_b32 v2, 6, v0
    v_and_b32 v1, 63, v0
    s_mov_b32 s50, 0x5d800000
    v_readfirstlane_b32 s16, v2
    v_mov_b32 v14, 147456
    v_mov_b32 v15, 0
    v_lshlrev_b32 v2, 4, v1
    ds_write2_b32 v14, v15, v15 offset0:0 offset1:1
    ds_write2_b32 v14, v15, v15 offset0:2 offset1:3
    s_waitcnt lgkmcnt(0)
    s_barrier
    s_mov_b32 s36, s14
    s_mov_b32 s37, s15
    s_mov_b32 s38, 8388608
    s_mov_b32 s39, 0x20000
    s_cmp_ge_u32 s16, 4
    s_cbranch_scc1 K2_GEMM
    s_setprio 3
    s_and_b32 s3, s2, 7
    s_lshl_b32 s3, s3, 5
    s_lshr_b32 s17, s2, 3
    s_or_b32 s3, s3, s17
    s_lshr_b32 s17, s3, 2
    s_and_b32 s18, s3, 3
    s_lshl_b32 s41, s16, 16
    s_add_u32 s41, s41, 2097152
    s_mov_b32 s40, 2097152
    v_and_b32 v3, 31, v1
    v_lshlrev_b32 v3, 2, v3
    s_lshl_b32 s42, s17, 7
    s_add_u32 s42, s42, 4194304
    v_cmp_lt_u32 s[46:47], 31, v1
    s_mov_b32 s20, s14
    s_mov_b32 s21, s15
    s_add_u32 s22, s41, 65536
    s_mov_b32 s23, 0x20000
    s_bfe_u32 s43, s2, 0x40003
    s_mov_b32 s56, s41
    s_add_u32 s57, s41, 65536
    s_mul_i32 s43, s43, 4096
    s_add_u32 s41, s41, s43
    buffer_load_dwordx4 v[208:211], v2, s[36:39], s40 offen offset:0
    buffer_load_dwordx4 v[212:215], v2, s[36:39], s40 offen offset:1024
    s_xor_b32 s43, s16, 0
    s_lshl_b32 s44, s3, 2
    s_add_u32 s43, s43, s44
    s_lshl_b32 s43, s43, 11
    buffer_load_dwordx4 v[16:19], v2, s[36:39], s43 offen offset:0
    buffer_load_dwordx4 v[20:23], v2, s[36:39], s43 offen offset:1024
    s_xor_b32 s43, s16, 1
    s_lshl_b32 s44, s3, 2
    s_add_u32 s43, s43, s44
    s_lshl_b32 s43, s43, 11
    buffer_load_dwordx4 v[24:27], v2, s[36:39], s43 offen offset:0
    buffer_load_dwordx4 v[28:31], v2, s[36:39], s43 offen offset:1024
    s_xor_b32 s43, s16, 2
    s_lshl_b32 s44, s3, 2
    s_add_u32 s43, s43, s44
    s_lshl_b32 s43, s43, 11
    buffer_load_dwordx4 v[32:35], v2, s[36:39], s43 offen offset:0
    buffer_load_dwordx4 v[36:39], v2, s[36:39], s43 offen offset:1024
    s_xor_b32 s43, s16, 3
    s_lshl_b32 s44, s3, 2
    s_add_u32 s43, s43, s44
    s_lshl_b32 s43, s43, 11
    buffer_load_dwordx4 v[40:43], v2, s[36:39], s43 offen offset:0
    buffer_load_dwordx4 v[44:47], v2, s[36:39], s43 offen offset:1024
    buffer_load_dword v4, v3, s[36:39], s42 offen
    buffer_load_dwordx4 v[112:115], v2, s[20:23], s41 offen offset:0
    buffer_load_dwordx4 v[116:119], v2, s[20:23], s41 offen offset:1024
    buffer_load_dwordx4 v[120:123], v2, s[20:23], s41 offen offset:2048
    buffer_load_dwordx4 v[124:127], v2, s[20:23], s41 offen offset:3072
    s_add_u32 s41, s41, 4096
    s_cmp_eq_u32 s41, s57
    s_cselect_b32 s41, s56, s41
    buffer_load_dwordx4 v[128:131], v2, s[20:23], s41 offen offset:0
    buffer_load_dwordx4 v[132:135], v2, s[20:23], s41 offen offset:1024
    buffer_load_dwordx4 v[136:139], v2, s[20:23], s41 offen offset:2048
    buffer_load_dwordx4 v[140:143], v2, s[20:23], s41 offen offset:3072
    s_add_u32 s41, s41, 4096
    s_cmp_eq_u32 s41, s57
    s_cselect_b32 s41, s56, s41
    buffer_load_dwordx4 v[144:147], v2, s[20:23], s41 offen offset:0
    buffer_load_dwordx4 v[148:151], v2, s[20:23], s41 offen offset:1024
    buffer_load_dwordx4 v[152:155], v2, s[20:23], s41 offen offset:2048
    buffer_load_dwordx4 v[156:159], v2, s[20:23], s41 offen offset:3072
    s_add_u32 s41, s41, 4096
    s_cmp_eq_u32 s41, s57
    s_cselect_b32 s41, s56, s41
    s_xor_b32 s43, s16, 0
    s_mul_i32 s43, s43, 12288
    s_add_u32 s43, s43, 94208
    v_lshl_add_u32 v8, v1, 4, s43
    s_xor_b32 s43, s16, 1
    s_mul_i32 s43, s43, 12288
    s_add_u32 s43, s43, 94208
    v_lshl_add_u32 v9, v1, 4, s43
    s_xor_b32 s43, s16, 2
    s_mul_i32 s43, s43, 12288
    s_add_u32 s43, s43, 94208
    v_lshl_add_u32 v10, v1, 4, s43
    s_xor_b32 s43, s16, 3
    s_mul_i32 s43, s43, 12288
    s_add_u32 s43, s43, 94208
    v_lshl_add_u32 v11, v1, 4, s43
    s_waitcnt vmcnt(19)
    v_mfma_f32_32x32x16_bf16 v[48:63], v[208:211], v[16:19], 0
    v_mfma_f32_32x32x16_bf16 v[48:63], v[212:215], v[20:23], v[48:63]
    s_waitcnt vmcnt(17)
    v_mfma_f32_32x32x16_bf16 v[64:79], v[208:211], v[24:27], 0
    v_mfma_f32_32x32x16_bf16 v[64:79], v[212:215], v[28:31], v[64:79]
    s_waitcnt vmcnt(15)
    v_mfma_f32_32x32x16_bf16 v[80:95], v[208:211], v[32:35], 0
    v_mfma_f32_32x32x16_bf16 v[80:95], v[212:215], v[36:39], v[80:95]
    s_waitcnt vmcnt(13)
    v_mfma_f32_32x32x16_bf16 v[96:111], v[208:211], v[40:43], 0
    v_mfma_f32_32x32x16_bf16 v[96:111], v[212:215], v[44:47], v[96:111]
    s_nop 6
    v_max3_f32 v5, v48, v49, v50
    v_max3_f32 v5, v5, v51, v52
    v_max3_f32 v5, v5, v53, v54
    v_max3_f32 v5, v5, v55, v56
    v_max3_f32 v5, v5, v57, v58
    v_max3_f32 v5, v5, v59, v60
    v_max3_f32 v5, v5, v61, v62
    v_max_f32 v5, v5, v63
    v_mov_b32 v6, v5
    s_nop 1
    v_permlane32_swap_b32 v5, v6
    v_max_f32 v5, v5, v6
    v_cvt_pk_bf16_f32 v5, -v5, 0
    v_cndmask_b32 v22, v22, v5, s[46:47]
    v_max3_f32 v5, v64, v65, v66
    v_max3_f32 v5, v5, v67, v68
    v_max3_f32 v5, v5, v69, v70
    v_max3_f32 v5, v5, v71, v72
    v_max3_f32 v5, v5, v73, v74
    v_max3_f32 v5, v5, v75, v76
    v_max3_f32 v5, v5, v77, v78
    v_max_f32 v5, v5, v79
    v_mov_b32 v6, v5
    s_nop 1
    v_permlane32_swap_b32 v5, v6
    v_max_f32 v5, v5, v6
    v_cvt_pk_bf16_f32 v5, -v5, 0
    v_cndmask_b32 v30, v30, v5, s[46:47]
    v_max3_f32 v5, v80, v81, v82
    v_max3_f32 v5, v5, v83, v84
    v_max3_f32 v5, v5, v85, v86
    v_max3_f32 v5, v5, v87, v88
    v_max3_f32 v5, v5, v89, v90
    v_max3_f32 v5, v5, v91, v92
    v_max3_f32 v5, v5, v93, v94
    v_max_f32 v5, v5, v95
    v_mov_b32 v6, v5
    s_nop 1
    v_permlane32_swap_b32 v5, v6
    v_max_f32 v5, v5, v6
    v_cvt_pk_bf16_f32 v5, -v5, 0
    v_cndmask_b32 v38, v38, v5, s[46:47]
    v_max3_f32 v5, v96, v97, v98
    v_max3_f32 v5, v5, v99, v100
    v_max3_f32 v5, v5, v101, v102
    v_max3_f32 v5, v5, v103, v104
    v_max3_f32 v5, v5, v105, v106
    v_max3_f32 v5, v5, v107, v108
    v_max3_f32 v5, v5, v109, v110
    v_max_f32 v5, v5, v111
    v_mov_b32 v6, v5
    s_nop 1
    v_permlane32_swap_b32 v5, v6
    v_max_f32 v5, v5, v6
    v_cvt_pk_bf16_f32 v5, -v5, 0
    v_cndmask_b32 v46, v46, v5, s[46:47]
    v_mov_b32 v48, 0
    v_mov_b32 v49, 0
    v_mov_b32 v50, 0
    v_mov_b32 v51, 0
    v_mov_b32 v52, 0
    v_mov_b32 v53, 0
    v_mov_b32 v54, 0
    v_mov_b32 v55, 0
    v_mov_b32 v56, 0
    v_mov_b32 v57, 0
    v_mov_b32 v58, 0
    v_mov_b32 v59, 0
    v_mov_b32 v60, 0
    v_mov_b32 v61, 0
    v_mov_b32 v62, 0
    v_mov_b32 v63, 0
    v_mov_b32 v64, 0
    v_mov_b32 v65, 0
    v_mov_b32 v66, 0
    v_mov_b32 v67, 0
    v_mov_b32 v68, 0
    v_mov_b32 v69, 0
    v_mov_b32 v70, 0
    v_mov_b32 v71, 0
    v_mov_b32 v72, 0
    v_mov_b32 v73, 0
    v_mov_b32 v74, 0
    v_mov_b32 v75, 0
    v_mov_b32 v76, 0
    v_mov_b32 v77, 0
    v_mov_b32 v78, 0
    v_mov_b32 v79, 0
    v_mov_b32 v80, 0
    v_mov_b32 v81, 0
    v_mov_b32 v82, 0
    v_mov_b32 v83, 0
    v_mov_b32 v84, 0
    v_mov_b32 v85, 0
    v_mov_b32 v86, 0
    v_mov_b32 v87, 0
    v_mov_b32 v88, 0
    v_mov_b32 v89, 0
    v_mov_b32 v90, 0
    v_mov_b32 v91, 0
    v_mov_b32 v92, 0
    v_mov_b32 v93, 0
    v_mov_b32 v94, 0
    v_mov_b32 v95, 0
    v_mov_b32 v96, 0
    v_mov_b32 v97, 0
    v_mov_b32 v98, 0
    v_mov_b32 v99, 0
    v_mov_b32 v100, 0
    v_mov_b32 v101, 0
    v_mov_b32 v102, 0
    v_mov_b32 v103, 0
    v_mov_b32 v104, 0
    v_mov_b32 v105, 0
    v_mov_b32 v106, 0
    v_mov_b32 v107, 0
    v_mov_b32 v108, 0
    v_mov_b32 v109, 0
    v_mov_b32 v110, 0
    v_mov_b32 v111, 0
    s_setprio 1
    s_waitcnt vmcnt(8)
    v_mfma_f32_32x32x16_bf16 v[176:191], v[112:115], v[16:19], 0
    v_mfma_f32_32x32x16_bf16 v[176:191], v[116:119], v[20:23], v[176:191]
    s_mov_b32 s45, 0
    s_cmp_lg_u32 s45, 0
    s_nop 7
    s_nop 1
K2_ALOOP:
    v_mfma_f32_32x32x16_bf16 v[192:207], v[112:115], v[24:27], 0
    v_exp_f32 v176, v176
    v_exp_f32 v177, v177
    v_exp_f32 v178, v178
    v_exp_f32 v179, v179
    v_mfma_f32_32x32x16_bf16 v[192:207], v[116:119], v[28:31], v[192:207]
    v_exp_f32 v180, v180
    v_exp_f32 v181, v181
    v_exp_f32 v182, v182
    v_exp_f32 v183, v183
    v_cvt_pk_bf16_f32 v208, v176, v177
    v_cvt_pk_bf16_f32 v209, v178, v179
    s_cbranch_scc0 K2_AENT
    v_mfma_f32_32x32x16_bf16 v[96:111], v[172:175], v[220:223], v[96:111]
K2_AENT:
    s_setprio 3
    buffer_load_dwordx4 v[160:163], v2, s[20:23], s41 offen offset:0
    buffer_load_dwordx4 v[164:167], v2, s[20:23], s41 offen offset:1024
    buffer_load_dwordx4 v[168:171], v2, s[20:23], s41 offen offset:2048
    buffer_load_dwordx4 v[172:175], v2, s[20:23], s41 offen offset:3072
    s_add_u32 s41, s41, 4096
    s_cmp_eq_u32 s41, s57
    s_cselect_b32 s41, s56, s41
    s_setprio 1
    v_exp_f32 v184, v184
    v_exp_f32 v185, v185
    v_exp_f32 v186, v186
    v_exp_f32 v187, v187
    v_cvt_pk_bf16_f32 v210, v180, v181
    v_cvt_pk_bf16_f32 v211, v182, v183
    v_exp_f32 v188, v188
    v_exp_f32 v189, v189
    v_mfma_f32_32x32x16_bf16 v[48:63], v[120:123], v[208:211], v[48:63]
    v_exp_f32 v190, v190
    v_exp_f32 v191, v191
    v_cvt_pk_bf16_f32 v212, v184, v185
    v_cvt_pk_bf16_f32 v213, v186, v187
    v_cvt_pk_bf16_f32 v214, v188, v189
    v_cvt_pk_bf16_f32 v215, v190, v191
    v_mfma_f32_32x32x16_bf16 v[176:191], v[112:115], v[32:35], 0
    v_exp_f32 v192, v192
    v_exp_f32 v193, v193
    v_exp_f32 v194, v194
    v_exp_f32 v195, v195
    v_mfma_f32_32x32x16_bf16 v[176:191], v[116:119], v[36:39], v[176:191]
    v_exp_f32 v196, v196
    v_exp_f32 v197, v197
    v_exp_f32 v198, v198
    v_exp_f32 v199, v199
    v_cvt_pk_bf16_f32 v216, v192, v193
    v_cvt_pk_bf16_f32 v217, v194, v195
    v_mfma_f32_32x32x16_bf16 v[48:63], v[124:127], v[212:215], v[48:63]
    v_exp_f32 v200, v200
    v_exp_f32 v201, v201
    v_exp_f32 v202, v202
    v_exp_f32 v203, v203
    v_cvt_pk_bf16_f32 v218, v196, v197
    v_cvt_pk_bf16_f32 v219, v198, v199
    v_exp_f32 v204, v204
    v_exp_f32 v205, v205
    v_mfma_f32_32x32x16_bf16 v[64:79], v[120:123], v[216:219], v[64:79]
    v_exp_f32 v206, v206
    v_exp_f32 v207, v207
    v_cvt_pk_bf16_f32 v220, v200, v201
    v_cvt_pk_bf16_f32 v221, v202, v203
    v_cvt_pk_bf16_f32 v222, v204, v205
    v_cvt_pk_bf16_f32 v223, v206, v207
    v_mfma_f32_32x32x16_bf16 v[192:207], v[112:115], v[40:43], 0
    v_exp_f32 v176, v176
    v_exp_f32 v177, v177
    v_exp_f32 v178, v178
    v_exp_f32 v179, v179
    v_mfma_f32_32x32x16_bf16 v[192:207], v[116:119], v[44:47], v[192:207]
    v_exp_f32 v180, v180
    v_exp_f32 v181, v181
    v_exp_f32 v182, v182
    v_exp_f32 v183, v183
    v_cvt_pk_bf16_f32 v208, v176, v177
    v_cvt_pk_bf16_f32 v209, v178, v179
    v_mfma_f32_32x32x16_bf16 v[64:79], v[124:127], v[220:223], v[64:79]
    v_exp_f32 v184, v184
    v_exp_f32 v185, v185
    v_exp_f32 v186, v186
    v_exp_f32 v187, v187
    v_cvt_pk_bf16_f32 v210, v180, v181
    v_cvt_pk_bf16_f32 v211, v182, v183
    v_exp_f32 v188, v188
    v_exp_f32 v189, v189
    v_mfma_f32_32x32x16_bf16 v[80:95], v[120:123], v[208:211], v[80:95]
    v_exp_f32 v190, v190
    v_exp_f32 v191, v191
    v_cvt_pk_bf16_f32 v212, v184, v185
    v_cvt_pk_bf16_f32 v213, v186, v187
    v_cvt_pk_bf16_f32 v214, v188, v189
    v_cvt_pk_bf16_f32 v215, v190, v191
    s_waitcnt vmcnt(8)
    v_mfma_f32_32x32x16_bf16 v[176:191], v[128:131], v[16:19], 0
    v_exp_f32 v192, v192
    v_exp_f32 v193, v193
    v_exp_f32 v194, v194
    v_exp_f32 v195, v195
    v_mfma_f32_32x32x16_bf16 v[176:191], v[132:135], v[20:23], v[176:191]
    v_exp_f32 v196, v196
    v_exp_f32 v197, v197
    v_exp_f32 v198, v198
    v_exp_f32 v199, v199
    v_cvt_pk_bf16_f32 v216, v192, v193
    v_cvt_pk_bf16_f32 v217, v194, v195
    v_mfma_f32_32x32x16_bf16 v[80:95], v[124:127], v[212:215], v[80:95]
    v_exp_f32 v200, v200
    v_exp_f32 v201, v201
    v_exp_f32 v202, v202
    v_exp_f32 v203, v203
    v_cvt_pk_bf16_f32 v218, v196, v197
    v_cvt_pk_bf16_f32 v219, v198, v199
    v_exp_f32 v204, v204
    v_exp_f32 v205, v205
    v_mfma_f32_32x32x16_bf16 v[96:111], v[120:123], v[216:219], v[96:111]
    v_exp_f32 v206, v206
    v_exp_f32 v207, v207
    v_cvt_pk_bf16_f32 v220, v200, v201
    v_cvt_pk_bf16_f32 v221, v202, v203
    v_cvt_pk_bf16_f32 v222, v204, v205
    v_cvt_pk_bf16_f32 v223, v206, v207
    v_mfma_f32_32x32x16_bf16 v[192:207], v[128:131], v[24:27], 0
    v_exp_f32 v176, v176
    v_exp_f32 v177, v177
    v_exp_f32 v178, v178
    v_exp_f32 v179, v179
    v_mfma_f32_32x32x16_bf16 v[192:207], v[132:135], v[28:31], v[192:207]
    v_exp_f32 v180, v180
    v_exp_f32 v181, v181
    v_exp_f32 v182, v182
    v_exp_f32 v183, v183
    v_cvt_pk_bf16_f32 v208, v176, v177
    v_cvt_pk_bf16_f32 v209, v178, v179
    v_mfma_f32_32x32x16_bf16 v[96:111], v[124:127], v[220:223], v[96:111]
    s_cmp_eq_u32 s45, 3
    s_cbranch_scc1 K2_SK4
    s_setprio 3
    buffer_load_dwordx4 v[112:115], v2, s[20:23], s41 offen offset:0
    buffer_load_dwordx4 v[116:119], v2, s[20:23], s41 offen offset:1024
    buffer_load_dwordx4 v[120:123], v2, s[20:23], s41 offen offset:2048
    buffer_load_dwordx4 v[124:127], v2, s[20:23], s41 offen offset:3072
    s_add_u32 s41, s41, 4096
    s_cmp_eq_u32 s41, s57
    s_cselect_b32 s41, s56, s41
    s_setprio 1
K2_SR4:
    v_exp_f32 v184, v184
    v_exp_f32 v185, v185
    v_exp_f32 v186, v186
    v_exp_f32 v187, v187
    v_cvt_pk_bf16_f32 v210, v180, v181
    v_cvt_pk_bf16_f32 v211, v182, v183
    v_exp_f32 v188, v188
    v_exp_f32 v189, v189
    v_mfma_f32_32x32x16_bf16 v[48:63], v[136:139], v[208:211], v[48:63]
    v_exp_f32 v190, v190
    v_exp_f32 v191, v191
    v_cvt_pk_bf16_f32 v212, v184, v185
    v_cvt_pk_bf16_f32 v213, v186, v187
    v_cvt_pk_bf16_f32 v214, v188, v189
    v_cvt_pk_bf16_f32 v215, v190, v191
    v_mfma_f32_32x32x16_bf16 v[176:191], v[128:131], v[32:35], 0
    v_exp_f32 v192, v192
    v_exp_f32 v193, v193
    v_exp_f32 v194, v194
    v_exp_f32 v195, v195
    v_mfma_f32_32x32x16_bf16 v[176:191], v[132:135], v[36:39], v[176:191]
    v_exp_f32 v196, v196
    v_exp_f32 v197, v197
    v_exp_f32 v198, v198
    v_exp_f32 v199, v199
    v_cvt_pk_bf16_f32 v216, v192, v193
    v_cvt_pk_bf16_f32 v217, v194, v195
    v_mfma_f32_32x32x16_bf16 v[48:63], v[140:143], v[212:215], v[48:63]
    v_exp_f32 v200, v200
    v_exp_f32 v201, v201
    v_exp_f32 v202, v202
    v_exp_f32 v203, v203
    v_cvt_pk_bf16_f32 v218, v196, v197
    v_cvt_pk_bf16_f32 v219, v198, v199
    v_exp_f32 v204, v204
    v_exp_f32 v205, v205
    v_mfma_f32_32x32x16_bf16 v[64:79], v[136:139], v[216:219], v[64:79]
    v_exp_f32 v206, v206
    v_exp_f32 v207, v207
    v_cvt_pk_bf16_f32 v220, v200, v201
    v_cvt_pk_bf16_f32 v221, v202, v203
    v_cvt_pk_bf16_f32 v222, v204, v205
    v_cvt_pk_bf16_f32 v223, v206, v207
    v_mfma_f32_32x32x16_bf16 v[192:207], v[128:131], v[40:43], 0
    v_exp_f32 v176, v176
    v_exp_f32 v177, v177
    v_exp_f32 v178, v178
    v_exp_f32 v179, v179
    v_mfma_f32_32x32x16_bf16 v[192:207], v[132:135], v[44:47], v[192:207]
    v_exp_f32 v180, v180
    v_exp_f32 v181, v181
    v_exp_f32 v182, v182
    v_exp_f32 v183, v183
    v_cvt_pk_bf16_f32 v208, v176, v177
    v_cvt_pk_bf16_f32 v209, v178, v179
    v_mfma_f32_32x32x16_bf16 v[64:79], v[140:143], v[220:223], v[64:79]
    v_exp_f32 v184, v184
    v_exp_f32 v185, v185
    v_exp_f32 v186, v186
    v_exp_f32 v187, v187
    v_cvt_pk_bf16_f32 v210, v180, v181
    v_cvt_pk_bf16_f32 v211, v182, v183
    v_exp_f32 v188, v188
    v_exp_f32 v189, v189
    v_mfma_f32_32x32x16_bf16 v[80:95], v[136:139], v[208:211], v[80:95]
    v_exp_f32 v190, v190
    v_exp_f32 v191, v191
    v_cvt_pk_bf16_f32 v212, v184, v185
    v_cvt_pk_bf16_f32 v213, v186, v187
    v_cvt_pk_bf16_f32 v214, v188, v189
    v_cvt_pk_bf16_f32 v215, v190, v191
    s_waitcnt vmcnt(8)
    v_mfma_f32_32x32x16_bf16 v[176:191], v[144:147], v[16:19], 0
    v_exp_f32 v192, v192
    v_exp_f32 v193, v193
    v_exp_f32 v194, v194
    v_exp_f32 v195, v195
    v_mfma_f32_32x32x16_bf16 v[176:191], v[148:151], v[20:23], v[176:191]
    v_exp_f32 v196, v196
    v_exp_f32 v197, v197
    v_exp_f32 v198, v198
    v_exp_f32 v199, v199
    v_cvt_pk_bf16_f32 v216, v192, v193
    v_cvt_pk_bf16_f32 v217, v194, v195
    v_mfma_f32_32x32x16_bf16 v[80:95], v[140:143], v[212:215], v[80:95]
    v_exp_f32 v200, v200
    v_exp_f32 v201, v201
    v_exp_f32 v202, v202
    v_exp_f32 v203, v203
    v_cvt_pk_bf16_f32 v218, v196, v197
    v_cvt_pk_bf16_f32 v219, v198, v199
    v_exp_f32 v204, v204
    v_exp_f32 v205, v205
    v_mfma_f32_32x32x16_bf16 v[96:111], v[136:139], v[216:219], v[96:111]
    v_exp_f32 v206, v206
    v_exp_f32 v207, v207
    v_cvt_pk_bf16_f32 v220, v200, v201
    v_cvt_pk_bf16_f32 v221, v202, v203
    v_cvt_pk_bf16_f32 v222, v204, v205
    v_cvt_pk_bf16_f32 v223, v206, v207
    v_mfma_f32_32x32x16_bf16 v[192:207], v[144:147], v[24:27], 0
    v_exp_f32 v176, v176
    v_exp_f32 v177, v177
    v_exp_f32 v178, v178
    v_exp_f32 v179, v179
    v_mfma_f32_32x32x16_bf16 v[192:207], v[148:151], v[28:31], v[192:207]
    v_exp_f32 v180, v180
    v_exp_f32 v181, v181
    v_exp_f32 v182, v182
    v_exp_f32 v183, v183
    v_cvt_pk_bf16_f32 v208, v176, v177
    v_cvt_pk_bf16_f32 v209, v178, v179
    v_mfma_f32_32x32x16_bf16 v[96:111], v[140:143], v[220:223], v[96:111]
    s_cmp_eq_u32 s45, 3
    s_cbranch_scc1 K2_SK8
    s_setprio 3
    buffer_load_dwordx4 v[128:131], v2, s[20:23], s41 offen offset:0
    buffer_load_dwordx4 v[132:135], v2, s[20:23], s41 offen offset:1024
    buffer_load_dwordx4 v[136:139], v2, s[20:23], s41 offen offset:2048
    buffer_load_dwordx4 v[140:143], v2, s[20:23], s41 offen offset:3072
    s_add_u32 s41, s41, 4096
    s_cmp_eq_u32 s41, s57
    s_cselect_b32 s41, s56, s41
    s_setprio 1
K2_SR8:
    v_exp_f32 v184, v184
    v_exp_f32 v185, v185
    v_exp_f32 v186, v186
    v_exp_f32 v187, v187
    v_cvt_pk_bf16_f32 v210, v180, v181
    v_cvt_pk_bf16_f32 v211, v182, v183
    v_exp_f32 v188, v188
    v_exp_f32 v189, v189
    v_mfma_f32_32x32x16_bf16 v[48:63], v[152:155], v[208:211], v[48:63]
    v_exp_f32 v190, v190
    v_exp_f32 v191, v191
    v_cvt_pk_bf16_f32 v212, v184, v185
    v_cvt_pk_bf16_f32 v213, v186, v187
    v_cvt_pk_bf16_f32 v214, v188, v189
    v_cvt_pk_bf16_f32 v215, v190, v191
    v_mfma_f32_32x32x16_bf16 v[176:191], v[144:147], v[32:35], 0
    v_exp_f32 v192, v192
    v_exp_f32 v193, v193
    v_exp_f32 v194, v194
    v_exp_f32 v195, v195
    v_mfma_f32_32x32x16_bf16 v[176:191], v[148:151], v[36:39], v[176:191]
    v_exp_f32 v196, v196
    v_exp_f32 v197, v197
    v_exp_f32 v198, v198
    v_exp_f32 v199, v199
    v_cvt_pk_bf16_f32 v216, v192, v193
    v_cvt_pk_bf16_f32 v217, v194, v195
    v_mfma_f32_32x32x16_bf16 v[48:63], v[156:159], v[212:215], v[48:63]
    v_exp_f32 v200, v200
    v_exp_f32 v201, v201
    v_exp_f32 v202, v202
    v_exp_f32 v203, v203
    v_cvt_pk_bf16_f32 v218, v196, v197
    v_cvt_pk_bf16_f32 v219, v198, v199
    v_exp_f32 v204, v204
    v_exp_f32 v205, v205
    v_mfma_f32_32x32x16_bf16 v[64:79], v[152:155], v[216:219], v[64:79]
    v_exp_f32 v206, v206
    v_exp_f32 v207, v207
    v_cvt_pk_bf16_f32 v220, v200, v201
    v_cvt_pk_bf16_f32 v221, v202, v203
    v_cvt_pk_bf16_f32 v222, v204, v205
    v_cvt_pk_bf16_f32 v223, v206, v207
    v_mfma_f32_32x32x16_bf16 v[192:207], v[144:147], v[40:43], 0
    v_exp_f32 v176, v176
    v_exp_f32 v177, v177
    v_exp_f32 v178, v178
    v_exp_f32 v179, v179
    v_mfma_f32_32x32x16_bf16 v[192:207], v[148:151], v[44:47], v[192:207]
    v_exp_f32 v180, v180
    v_exp_f32 v181, v181
    v_exp_f32 v182, v182
    v_exp_f32 v183, v183
    v_cvt_pk_bf16_f32 v208, v176, v177
    v_cvt_pk_bf16_f32 v209, v178, v179
    v_mfma_f32_32x32x16_bf16 v[64:79], v[156:159], v[220:223], v[64:79]
    v_exp_f32 v184, v184
    v_exp_f32 v185, v185
    v_exp_f32 v186, v186
    v_exp_f32 v187, v187
    v_cvt_pk_bf16_f32 v210, v180, v181
    v_cvt_pk_bf16_f32 v211, v182, v183
    v_exp_f32 v188, v188
    v_exp_f32 v189, v189
    v_mfma_f32_32x32x16_bf16 v[80:95], v[152:155], v[208:211], v[80:95]
    v_exp_f32 v190, v190
    v_exp_f32 v191, v191
    v_cvt_pk_bf16_f32 v212, v184, v185
    v_cvt_pk_bf16_f32 v213, v186, v187
    v_cvt_pk_bf16_f32 v214, v188, v189
    v_cvt_pk_bf16_f32 v215, v190, v191
    s_waitcnt vmcnt(8)
    v_mfma_f32_32x32x16_bf16 v[176:191], v[160:163], v[16:19], 0
    v_exp_f32 v192, v192
    v_exp_f32 v193, v193
    v_exp_f32 v194, v194
    v_exp_f32 v195, v195
    v_mfma_f32_32x32x16_bf16 v[176:191], v[164:167], v[20:23], v[176:191]
    v_exp_f32 v196, v196
    v_exp_f32 v197, v197
    v_exp_f32 v198, v198
    v_exp_f32 v199, v199
    v_cvt_pk_bf16_f32 v216, v192, v193
    v_cvt_pk_bf16_f32 v217, v194, v195
    v_mfma_f32_32x32x16_bf16 v[80:95], v[156:159], v[212:215], v[80:95]
    v_exp_f32 v200, v200
    v_exp_f32 v201, v201
    v_exp_f32 v202, v202
    v_exp_f32 v203, v203
    v_cvt_pk_bf16_f32 v218, v196, v197
    v_cvt_pk_bf16_f32 v219, v198, v199
    v_exp_f32 v204, v204
    v_exp_f32 v205, v205
    v_mfma_f32_32x32x16_bf16 v[96:111], v[152:155], v[216:219], v[96:111]
    v_exp_f32 v206, v206
    v_exp_f32 v207, v207
    v_cvt_pk_bf16_f32 v220, v200, v201
    v_cvt_pk_bf16_f32 v221, v202, v203
    v_cvt_pk_bf16_f32 v222, v204, v205
    v_cvt_pk_bf16_f32 v223, v206, v207
    v_mfma_f32_32x32x16_bf16 v[192:207], v[160:163], v[24:27], 0
    v_exp_f32 v176, v176
    v_exp_f32 v177, v177
    v_exp_f32 v178, v178
    v_exp_f32 v179, v179
    v_mfma_f32_32x32x16_bf16 v[192:207], v[164:167], v[28:31], v[192:207]
    v_exp_f32 v180, v180
    v_exp_f32 v181, v181
    v_exp_f32 v182, v182
    v_exp_f32 v183, v183
    v_cvt_pk_bf16_f32 v208, v176, v177
    v_cvt_pk_bf16_f32 v209, v178, v179
    v_mfma_f32_32x32x16_bf16 v[96:111], v[156:159], v[220:223], v[96:111]
    s_cmp_eq_u32 s45, 3
    s_cbranch_scc1 K2_SK12
    s_setprio 3
    buffer_load_dwordx4 v[144:147], v2, s[20:23], s41 offen offset:0
    buffer_load_dwordx4 v[148:151], v2, s[20:23], s41 offen offset:1024
    buffer_load_dwordx4 v[152:155], v2, s[20:23], s41 offen offset:2048
    buffer_load_dwordx4 v[156:159], v2, s[20:23], s41 offen offset:3072
    s_add_u32 s41, s41, 4096
    s_cmp_eq_u32 s41, s57
    s_cselect_b32 s41, s56, s41
    s_setprio 1
K2_SR12:
    v_exp_f32 v184, v184
    v_exp_f32 v185, v185
    v_exp_f32 v186, v186
    v_exp_f32 v187, v187
    v_cvt_pk_bf16_f32 v210, v180, v181
    v_cvt_pk_bf16_f32 v211, v182, v183
    v_exp_f32 v188, v188
    v_exp_f32 v189, v189
    v_mfma_f32_32x32x16_bf16 v[48:63], v[168:171], v[208:211], v[48:63]
    v_exp_f32 v190, v190
    v_exp_f32 v191, v191
    v_cvt_pk_bf16_f32 v212, v184, v185
    v_cvt_pk_bf16_f32 v213, v186, v187
    v_cvt_pk_bf16_f32 v214, v188, v189
    v_cvt_pk_bf16_f32 v215, v190, v191
    v_mfma_f32_32x32x16_bf16 v[176:191], v[160:163], v[32:35], 0
    v_exp_f32 v192, v192
    v_exp_f32 v193, v193
    v_exp_f32 v194, v194
    v_exp_f32 v195, v195
    v_mfma_f32_32x32x16_bf16 v[176:191], v[164:167], v[36:39], v[176:191]
    v_exp_f32 v196, v196
    v_exp_f32 v197, v197
    v_exp_f32 v198, v198
    v_exp_f32 v199, v199
    v_cvt_pk_bf16_f32 v216, v192, v193
    v_cvt_pk_bf16_f32 v217, v194, v195
    v_mfma_f32_32x32x16_bf16 v[48:63], v[172:175], v[212:215], v[48:63]
    v_exp_f32 v200, v200
    v_exp_f32 v201, v201
    v_exp_f32 v202, v202
    v_exp_f32 v203, v203
    v_cvt_pk_bf16_f32 v218, v196, v197
    v_cvt_pk_bf16_f32 v219, v198, v199
    v_exp_f32 v204, v204
    v_exp_f32 v205, v205
    v_mfma_f32_32x32x16_bf16 v[64:79], v[168:171], v[216:219], v[64:79]
    v_exp_f32 v206, v206
    v_exp_f32 v207, v207
    v_cvt_pk_bf16_f32 v220, v200, v201
    v_cvt_pk_bf16_f32 v221, v202, v203
    v_cvt_pk_bf16_f32 v222, v204, v205
    v_cvt_pk_bf16_f32 v223, v206, v207
    v_mfma_f32_32x32x16_bf16 v[192:207], v[160:163], v[40:43], 0
    v_exp_f32 v176, v176
    v_exp_f32 v177, v177
    v_exp_f32 v178, v178
    v_exp_f32 v179, v179
    v_mfma_f32_32x32x16_bf16 v[192:207], v[164:167], v[44:47], v[192:207]
    v_exp_f32 v180, v180
    v_exp_f32 v181, v181
    v_exp_f32 v182, v182
    v_exp_f32 v183, v183
    v_cvt_pk_bf16_f32 v208, v176, v177
    v_cvt_pk_bf16_f32 v209, v178, v179
    v_mfma_f32_32x32x16_bf16 v[64:79], v[172:175], v[220:223], v[64:79]
    v_exp_f32 v184, v184
    v_exp_f32 v185, v185
    v_exp_f32 v186, v186
    v_exp_f32 v187, v187
    v_cvt_pk_bf16_f32 v210, v180, v181
    v_cvt_pk_bf16_f32 v211, v182, v183
    v_exp_f32 v188, v188
    v_exp_f32 v189, v189
    v_mfma_f32_32x32x16_bf16 v[80:95], v[168:171], v[208:211], v[80:95]
    v_exp_f32 v190, v190
    v_exp_f32 v191, v191
    v_cvt_pk_bf16_f32 v212, v184, v185
    v_cvt_pk_bf16_f32 v213, v186, v187
    v_cvt_pk_bf16_f32 v214, v188, v189
    v_cvt_pk_bf16_f32 v215, v190, v191
    s_waitcnt vmcnt(8)
    v_mfma_f32_32x32x16_bf16 v[176:191], v[112:115], v[16:19], 0
    v_exp_f32 v192, v192
    v_exp_f32 v193, v193
    v_exp_f32 v194, v194
    v_exp_f32 v195, v195
    v_mfma_f32_32x32x16_bf16 v[176:191], v[116:119], v[20:23], v[176:191]
    v_exp_f32 v196, v196
    v_exp_f32 v197, v197
    v_exp_f32 v198, v198
    v_exp_f32 v199, v199
    v_cvt_pk_bf16_f32 v216, v192, v193
    v_cvt_pk_bf16_f32 v217, v194, v195
    v_mfma_f32_32x32x16_bf16 v[80:95], v[172:175], v[212:215], v[80:95]
    v_exp_f32 v200, v200
    v_exp_f32 v201, v201
    v_exp_f32 v202, v202
    v_exp_f32 v203, v203
    v_cvt_pk_bf16_f32 v218, v196, v197
    v_cvt_pk_bf16_f32 v219, v198, v199
    v_exp_f32 v204, v204
    v_exp_f32 v205, v205
    v_mfma_f32_32x32x16_bf16 v[96:111], v[168:171], v[216:219], v[96:111]
    v_exp_f32 v206, v206
    v_exp_f32 v207, v207
    v_cvt_pk_bf16_f32 v220, v200, v201
    v_cvt_pk_bf16_f32 v221, v202, v203
    v_cvt_pk_bf16_f32 v222, v204, v205
    v_cvt_pk_bf16_f32 v223, v206, v207
    s_add_u32 s45, s45, 1
    s_cmp_lt_u32 s45, 4
    s_cbranch_scc1 K2_ALOOP
    v_mfma_f32_32x32x16_bf16 v[96:111], v[172:175], v[220:223], v[96:111]
    s_setprio 3
LW1:
    ds_read_b32 v5, v14 offset:4
    s_waitcnt lgkmcnt(0)
    v_readfirstlane_b32 s54, v5
    s_cmp_lt_u32 s54, 4
    s_cbranch_scc1 LW1
    s_nop 7
    ds_write_b128 v8, v[64:67] offset:4096
    ds_write_b128 v8, v[68:71] offset:5120
    ds_write_b128 v8, v[72:75] offset:6144
    ds_write_b128 v8, v[76:79] offset:7168
    ds_write_b128 v8, v[80:83] offset:8192
    ds_write_b128 v8, v[84:87] offset:9216
    ds_write_b128 v8, v[88:91] offset:10240
    ds_write_b128 v8, v[92:95] offset:11264
    ds_write_b128 v8, v[96:99] offset:12288
    ds_write_b128 v8, v[100:103] offset:13312
    ds_write_b128 v8, v[104:107] offset:14336
    ds_write_b128 v8, v[108:111] offset:15360
    v_mov_b32 v5, 1
    s_waitcnt lgkmcnt(0)
    s_mov_b64 exec, 1
    ds_add_u32 v14, v5 offset:8
    s_mov_b64 exec, -1
LW2:
    ds_read_b32 v5, v14 offset:8
    s_waitcnt lgkmcnt(0)
    v_readfirstlane_b32 s54, v5
    s_cmp_lt_u32 s54, 4
    s_cbranch_scc1 LW2
    ds_read_b128 v[64:67], v9 offset:4096
    ds_read_b128 v[68:71], v9 offset:5120
    ds_read_b128 v[72:75], v9 offset:6144
    ds_read_b128 v[76:79], v9 offset:7168
    ds_read_b128 v[80:83], v10 offset:8192
    ds_read_b128 v[84:87], v10 offset:9216
    ds_read_b128 v[88:91], v10 offset:10240
    ds_read_b128 v[92:95], v10 offset:11264
    ds_read_b128 v[96:99], v11 offset:12288
    ds_read_b128 v[100:103], v11 offset:13312
    ds_read_b128 v[104:107], v11 offset:14336
    ds_read_b128 v[108:111], v11 offset:15360
    s_waitcnt lgkmcnt(8)
    v_pk_add_f32 v[48:49], v[48:49], v[64:65]
    v_pk_add_f32 v[50:51], v[50:51], v[66:67]
    v_pk_add_f32 v[52:53], v[52:53], v[68:69]
    v_pk_add_f32 v[54:55], v[54:55], v[70:71]
    v_pk_add_f32 v[56:57], v[56:57], v[72:73]
    v_pk_add_f32 v[58:59], v[58:59], v[74:75]
    v_pk_add_f32 v[60:61], v[60:61], v[76:77]
    v_pk_add_f32 v[62:63], v[62:63], v[78:79]
    s_waitcnt lgkmcnt(4)
    v_pk_add_f32 v[48:49], v[48:49], v[80:81]
    v_pk_add_f32 v[50:51], v[50:51], v[82:83]
    v_pk_add_f32 v[52:53], v[52:53], v[84:85]
    v_pk_add_f32 v[54:55], v[54:55], v[86:87]
    v_pk_add_f32 v[56:57], v[56:57], v[88:89]
    v_pk_add_f32 v[58:59], v[58:59], v[90:91]
    v_pk_add_f32 v[60:61], v[60:61], v[92:93]
    v_pk_add_f32 v[62:63], v[62:63], v[94:95]
    s_waitcnt lgkmcnt(0)
    v_pk_add_f32 v[48:49], v[48:49], v[96:97]
    v_pk_add_f32 v[50:51], v[50:51], v[98:99]
    v_pk_add_f32 v[52:53], v[52:53], v[100:101]
    v_pk_add_f32 v[54:55], v[54:55], v[102:103]
    v_pk_add_f32 v[56:57], v[56:57], v[104:105]
    v_pk_add_f32 v[58:59], v[58:59], v[106:107]
    v_pk_add_f32 v[60:61], v[60:61], v[108:109]
    v_pk_add_f32 v[62:63], v[62:63], v[110:111]
    v_mov_b32 v6, v60
    v_mov_b32 v7, v60
    v_pk_mul_f32 v[12:13], v[48:49], 0
    v_pk_fma_f32 v[12:13], v[50:51], 0, v[12:13]
    v_pk_fma_f32 v[12:13], v[52:53], 0, v[12:13]
    v_pk_fma_f32 v[12:13], v[54:55], 0, v[12:13]
    v_pk_fma_f32 v[12:13], v[56:57], 0, v[12:13]
    v_pk_fma_f32 v[12:13], v[58:59], 0, v[12:13]
    v_pk_fma_f32 v[12:13], v[60:61], 0, v[12:13]
    v_pk_fma_f32 v[12:13], v[62:63], 0, v[12:13]
    v_permlane32_swap_b32 v6, v7
    v_cmp_nlt_f32 vcc, 0x30800000, v7
    v_cmp_ngt_f32 s[48:49], s50, v7
    v_cmp_u_f32 s[52:53], v12, v13
    s_or_b64 vcc, vcc, s[48:49]
    s_or_b64 vcc, vcc, s[52:53]
    s_cbranch_vccnz K2_SLOW
K2_NORM:
    v_rcp_f32 v7, v7
    s_lshr_b32 s43, s17, 1
    s_lshl_b32 s43, s43, 16
    v_mul_f32 v6, v7, v4
    s_lshl_b32 s44, s18, 2
    s_add_u32 s44, s44, s16
    s_lshl_b32 s44, s44, 12
    s_add_u32 s43, s43, s44
    s_and_b32 s44, s17, 1
    s_lshl_b32 s44, s44, 10
    s_add_u32 s43, s43, s44
    s_add_u32 s43, s43, 6291456
    v_pk_mul_f32 v[48:49], v[48:49], v[6:7] op_sel_hi:[1,0]
    v_cvt_pk_bf16_f32 v208, v48, v49
    v_pk_mul_f32 v[50:51], v[50:51], v[6:7] op_sel_hi:[1,0]
    v_cvt_pk_bf16_f32 v209, v50, v51
    v_pk_mul_f32 v[52:53], v[52:53], v[6:7] op_sel_hi:[1,0]
    v_cvt_pk_bf16_f32 v210, v52, v53
    v_pk_mul_f32 v[54:55], v[54:55], v[6:7] op_sel_hi:[1,0]
    v_cvt_pk_bf16_f32 v211, v54, v55
    v_pk_mul_f32 v[56:57], v[56:57], v[6:7] op_sel_hi:[1,0]
    v_cvt_pk_bf16_f32 v212, v56, v57
    v_pk_mul_f32 v[58:59], v[58:59], v[6:7] op_sel_hi:[1,0]
    v_cvt_pk_bf16_f32 v213, v58, v59
    v_pk_mul_f32 v[60:61], v[60:61], v[6:7] op_sel_hi:[1,0]
    v_cvt_pk_bf16_f32 v214, v60, v61
    v_pk_mul_f32 v[62:63], v[62:63], v[6:7] op_sel_hi:[1,0]
    v_cvt_pk_bf16_f32 v215, v62, v63
    v_cndmask_b32 v214, v214, 0, s[46:47]
    v_cndmask_b32 v215, v215, 0, s[46:47]
    buffer_store_dwordx4 v[208:211], v2, s[36:39], s43 offen sc1
    buffer_store_dwordx4 v[212:215], v2, s[36:39], s43 offen offset:2048 sc1
    s_lshl_b32 s43, s3, 5
    s_add_u32 s43, s43, s16
    s_lshl_b32 s43, s43, 2
    s_add_u32 s43, s43, 5931008
    v_mov_b32 v5, 1
    s_waitcnt vmcnt(0)
    s_mov_b64 exec, 1
    buffer_store_dword v5, v15, s[36:39], s43 offen sc1
    s_mov_b64 exec, -1
    s_branch K2_FIN
K2_SK4:
    s_waitcnt vmcnt(4)
    s_branch K2_SR4
K2_SK8:
    s_waitcnt vmcnt(0)
    s_branch K2_SR8
K2_SK12:
    s_waitcnt vmcnt(0)
    s_branch K2_SR12
K2_SLOW:
    v_cndmask_b32 v22, v22, 0, s[46:47]
    v_mov_b32 v5, 0xff800000
    s_mov_b32 s41, 2097152
    s_mov_b32 s22, 2359296
K2_S1:
    buffer_load_dwordx4 v[112:115], v2, s[20:23], s41 offen offset:0
    buffer_load_dwordx4 v[116:119], v2, s[20:23], s41 offen offset:1024
    buffer_load_dwordx4 v[120:123], v2, s[20:23], s41 offen offset:2048
    buffer_load_dwordx4 v[124:127], v2, s[20:23], s41 offen offset:3072
    s_add_u32 s41, s41, 4096
    s_waitcnt vmcnt(0)
    v_mfma_f32_32x32x16_bf16 v[176:191], v[112:115], v[16:19], 0
    v_mfma_f32_32x32x16_bf16 v[176:191], v[116:119], v[20:23], v[176:191]
    s_nop 7
    s_nop 5
    v_max3_f32 v5, v5, v176, v177
    v_max3_f32 v5, v5, v178, v179
    v_max3_f32 v5, v5, v180, v181
    v_max3_f32 v5, v5, v182, v183
    v_max3_f32 v5, v5, v184, v185
    v_max3_f32 v5, v5, v186, v187
    v_max3_f32 v5, v5, v188, v189
    v_max3_f32 v5, v5, v190, v191
    s_cmp_lt_u32 s41, s22
    s_cbranch_scc1 K2_S1
    v_mov_b32 v6, v5
    s_nop 1
    v_permlane32_swap_b32 v5, v6
    v_max_f32 v5, v5, v6
    v_and_b32 v6, 0xffff0000, v5
    v_sub_f32 v5, v5, v6
    v_and_b32 v7, 0xffff0000, v5
    v_sub_f32 v5, v5, v7
    v_cvt_pk_bf16_f32 v6, -v6, -v7
    v_cvt_pk_bf16_f32 v5, -v5, 0
    v_cndmask_b32 v22, v22, v6, s[46:47]
    v_cndmask_b32 v23, v23, v5, s[46:47]
    s_mov_b32 s41, 2097152
    v_mov_b32 v48, 0
    v_mov_b32 v49, 0
    v_mov_b32 v50, 0
    v_mov_b32 v51, 0
    v_mov_b32 v52, 0
    v_mov_b32 v53, 0
    v_mov_b32 v54, 0
    v_mov_b32 v55, 0
    v_mov_b32 v56, 0
    v_mov_b32 v57, 0
    v_mov_b32 v58, 0
    v_mov_b32 v59, 0
    v_mov_b32 v60, 0
    v_mov_b32 v61, 0
    v_mov_b32 v62, 0
    v_mov_b32 v63, 0
K2_S2:
    buffer_load_dwordx4 v[112:115], v2, s[20:23], s41 offen offset:0
    buffer_load_dwordx4 v[116:119], v2, s[20:23], s41 offen offset:1024
    buffer_load_dwordx4 v[120:123], v2, s[20:23], s41 offen offset:2048
    buffer_load_dwordx4 v[124:127], v2, s[20:23], s41 offen offset:3072
    s_add_u32 s41, s41, 4096
    s_waitcnt vmcnt(0)
    v_mfma_f32_32x32x16_bf16 v[176:191], v[112:115], v[16:19], 0
    v_mfma_f32_32x32x16_bf16 v[176:191], v[116:119], v[20:23], v[176:191]
    s_nop 7
    s_nop 5
    v_exp_f32 v176, v176
    v_exp_f32 v177, v177
    v_exp_f32 v178, v178
    v_exp_f32 v179, v179
    v_exp_f32 v180, v180
    v_exp_f32 v181, v181
    v_exp_f32 v182, v182
    v_exp_f32 v183, v183
    v_exp_f32 v184, v184
    v_exp_f32 v185, v185
    v_exp_f32 v186, v186
    v_exp_f32 v187, v187
    v_exp_f32 v188, v188
    v_exp_f32 v189, v189
    v_exp_f32 v190, v190
    v_exp_f32 v191, v191
    v_cvt_pk_bf16_f32 v208, v176, v177
    v_cvt_pk_bf16_f32 v209, v178, v179
    v_cvt_pk_bf16_f32 v210, v180, v181
    v_cvt_pk_bf16_f32 v211, v182, v183
    v_cvt_pk_bf16_f32 v212, v184, v185
    v_cvt_pk_bf16_f32 v213, v186, v187
    v_cvt_pk_bf16_f32 v214, v188, v189
    v_cvt_pk_bf16_f32 v215, v190, v191
    s_nop 1
    v_mfma_f32_32x32x16_bf16 v[48:63], v[120:123], v[208:211], v[48:63]
    v_mfma_f32_32x32x16_bf16 v[48:63], v[124:127], v[212:215], v[48:63]
    s_cmp_lt_u32 s41, s22
    s_cbranch_scc1 K2_S2
    s_nop 7
    s_nop 5
    v_mov_b32 v6, v60
    v_mov_b32 v7, v60
    s_nop 1
    v_permlane32_swap_b32 v6, v7
    s_nop 1
    s_branch K2_NORM
K2_GEMM:
    s_setprio 2
    s_sub_u32 s16, s16, 4
    s_lshr_b32 s42, s16, 1
    s_and_b32 s43, s16, 1
    s_mul_i32 s44, s16, 24576
    s_lshl_b32 s46, s43, 10
    v_add_u32 v6, s46, v2
    v_xor_b32 v7, 1024, v6
    v_lshrrev_b32 v3, 5, v1
    v_lshlrev_b32 v12, 9, v3
    v_bfe_u32 v3, v1, 2, 2
    v_lshl_add_u32 v12, v3, 7, v12
    v_lshrrev_b32 v3, 1, v3
    v_xor_b32 v3, s42, v3
    v_lshl_add_u32 v12, v3, 6, v12
    v_bfe_u32 v3, v1, 4, 1
    v_lshl_add_u32 v12, v3, 5, v12
    v_and_b32 v3, 3, v1
    v_lshl_add_u32 v12, v3, 3, v12
    v_add_u32 v12, s44, v12
    v_xor_b32 v13, 64, v12
    s_mov_b32 s76, s12
    s_mov_b32 s77, s13
    s_mov_b32 s78, 401408
    s_mov_b32 s79, 0x20000
    s_mov_b32 s80, s28
    s_mov_b32 s81, s29
    s_mov_b32 s82, 1835008
    s_mov_b32 s83, 0x20000
    s_and_b32 s17, s2, 7
    s_mul_i32 s18, s17, 49
    s_add_u32 s19, s18, 50
    s_add_u32 s18, s18, 1
    s_lshr_b32 s18, s18, 1
    s_lshr_b32 s19, s19, 1
    s_lshr_b32 s17, s2, 3
    s_add_u32 s17, s17, s18
    s_cmp_ge_u32 s17, s19
    s_cbranch_scc1 K2_PF
    s_mul_i32 s18, s17, 9363
    s_lshr_b32 s18, s18, 16
    s_mul_i32 s19, s18, 7
    s_sub_u32 s19, s17, s19
    s_mul_i32 s40, s16, 1835008
    s_lshl_b32 s45, s18, 7
    s_add_u32 s40, s40, s45
    s_lshl_b32 s41, s19, 18
    s_lshl_b32 s46, s16, 16
    s_add_u32 s41, s41, s46
    s_add_u32 s41, s41, 2359296
    v_lshrrev_b32 v3, 3, v1
    s_mov_b32 s47, 3584
    v_mul_lo_u32 v4, v3, s47
    v_lshlrev_b32 v3, 1, v3
    v_and_b32 v3, 4, v3
    v_xor_b32 v3, v3, v1
    v_and_b32 v3, 7, v3
    v_lshl_add_u32 v4, v3, 4, v4
    v_add_u32 v5, 27648, v4
    v_lshrrev_b32 v3, 5, v1
    v_lshlrev_b32 v3, 3, v3
    s_lshl_b32 s46, s42, 6
    s_add_u32 s46, s46, s45
    s_mov_b32 s20, s4
    s_mov_b32 s21, s5
    s_mov_b32 s22, 7340032
    s_mov_b32 s23, 0x20000
    s_mov_b32 s24, s6
    s_mov_b32 s25, s7
    s_mov_b32 s26, 3584
    s_mov_b32 s27, 0x20000
    buffer_load_dwordx2 v[16:17], v3, s[24:27], s46 offen offset:0
    buffer_load_dwordx2 v[18:19], v3, s[24:27], s46 offen offset:16
    buffer_load_dwordx2 v[20:21], v3, s[24:27], s46 offen offset:32
    buffer_load_dwordx2 v[22:23], v3, s[24:27], s46 offen offset:48
    s_xor_b32 s47, s16, 0
    s_mul_i32 s47, s47, 12288
    s_add_u32 s47, s47, 94208
    v_lshl_add_u32 v8, v1, 4, s47
    s_xor_b32 s47, s16, 1
    s_mul_i32 s47, s47, 12288
    s_add_u32 s47, s47, 94208
    v_lshl_add_u32 v9, v1, 4, s47
    s_xor_b32 s47, s16, 2
    s_mul_i32 s47, s47, 12288
    s_add_u32 s47, s47, 94208
    v_lshl_add_u32 v10, v1, 4, s47
    s_xor_b32 s47, s16, 3
    s_mul_i32 s47, s47, 12288
    s_add_u32 s47, s47, 94208
    v_lshl_add_u32 v11, v1, 4, s47
    s_add_u32 m0, s44, 0
    buffer_load_dwordx4 v[112:115], v6, s[36:39], s41 offen
    buffer_load_dwordx4 v4, s[20:23], s40 offen lds
    buffer_load_dwordx4 v[116:119], v7, s[36:39], s41 offen
    s_add_u32 s41, s41, 2048
    buffer_load_dwordx4 v5, s[20:23], s40 offen offset:1024 lds
    s_add_u32 s40, s40, 57344
    s_add_u32 m0, s44, 2048
    buffer_load_dwordx4 v[120:123], v6, s[36:39], s41 offen
    buffer_load_dwordx4 v4, s[20:23], s40 offen lds
    buffer_load_dwordx4 v[124:127], v7, s[36:39], s41 offen
    s_add_u32 s41, s41, 2048
    buffer_load_dwordx4 v5, s[20:23], s40 offen offset:1024 lds
    s_add_u32 s40, s40, 57344
    s_add_u32 m0, s44, 4096
    buffer_load_dwordx4 v[128:131], v6, s[36:39], s41 offen
    buffer_load_dwordx4 v4, s[20:23], s40 offen lds
    buffer_load_dwordx4 v[132:135], v7, s[36:39], s41 offen
    s_add_u32 s41, s41, 2048
    buffer_load_dwordx4 v5, s[20:23], s40 offen offset:1024 lds
    s_add_u32 s40, s40, 57344
    s_add_u32 m0, s44, 6144
    buffer_load_dwordx4 v[136:139], v6, s[36:39], s41 offen
    buffer_load_dwordx4 v4, s[20:23], s40 offen lds
    buffer_load_dwordx4 v[140:143], v7, s[36:39], s41 offen
    s_add_u32 s41, s41, 2048
    buffer_load_dwordx4 v5, s[20:23], s40 offen offset:1024 lds
    s_add_u32 s40, s40, 57344
    s_add_u32 m0, s44, 8192
    buffer_load_dwordx4 v[144:147], v6, s[36:39], s41 offen
    buffer_load_dwordx4 v4, s[20:23], s40 offen lds
    buffer_load_dwordx4 v[148:151], v7, s[36:39], s41 offen
    s_add_u32 s41, s41, 2048
    buffer_load_dwordx4 v5, s[20:23], s40 offen offset:1024 lds
    s_add_u32 s40, s40, 57344
    s_add_u32 m0, s44, 10240
    buffer_load_dwordx4 v[152:155], v6, s[36:39], s41 offen
    buffer_load_dwordx4 v4, s[20:23], s40 offen lds
    buffer_load_dwordx4 v[156:159], v7, s[36:39], s41 offen
    s_add_u32 s41, s41, 2048
    buffer_load_dwordx4 v5, s[20:23], s40 offen offset:1024 lds
    s_add_u32 s40, s40, 57344
    s_add_u32 m0, s44, 12288
    buffer_load_dwordx4 v[160:163], v6, s[36:39], s41 offen
    buffer_load_dwordx4 v4, s[20:23], s40 offen lds
    buffer_load_dwordx4 v[164:167], v7, s[36:39], s41 offen
    s_add_u32 s41, s41, 2048
    buffer_load_dwordx4 v5, s[20:23], s40 offen offset:1024 lds
    s_add_u32 s40, s40, 57344
    s_add_u32 m0, s44, 14336
    buffer_load_dwordx4 v[168:171], v6, s[36:39], s41 offen
    buffer_load_dwordx4 v4, s[20:23], s40 offen lds
    buffer_load_dwordx4 v[172:175], v7, s[36:39], s41 offen
    s_add_u32 s41, s41, 2048
    buffer_load_dwordx4 v5, s[20:23], s40 offen offset:1024 lds
    s_add_u32 s40, s40, 57344
    s_add_u32 m0, s44, 16384
    buffer_load_dwordx4 v[176:179], v6, s[36:39], s41 offen
    buffer_load_dwordx4 v4, s[20:23], s40 offen lds
    buffer_load_dwordx4 v[180:183], v7, s[36:39], s41 offen
    s_add_u32 s41, s41, 2048
    buffer_load_dwordx4 v5, s[20:23], s40 offen offset:1024 lds
    s_add_u32 s40, s40, 57344
    s_add_u32 m0, s44, 18432
    buffer_load_dwordx4 v[184:187], v6, s[36:39], s41 offen
    buffer_load_dwordx4 v4, s[20:23], s40 offen lds
    buffer_load_dwordx4 v[188:191], v7, s[36:39], s41 offen
    s_add_u32 s41, s41, 2048
    buffer_load_dwordx4 v5, s[20:23], s40 offen offset:1024 lds
    s_add_u32 s40, s40, 57344
    s_add_u32 m0, s44, 20480
    buffer_load_dwordx4 v[192:195], v6, s[36:39], s41 offen
    buffer_load_dwordx4 v4, s[20:23], s40 offen lds
    buffer_load_dwordx4 v[196:199], v7, s[36:39], s41 offen
    s_add_u32 s41, s41, 2048
    buffer_load_dwordx4 v5, s[20:23], s40 offen offset:1024 lds
    s_add_u32 s40, s40, 57344
    s_add_u32 m0, s44, 22528
    buffer_load_dwordx4 v[200:203], v6, s[36:39], s41 offen
    buffer_load_dwordx4 v4, s[20:23], s40 offen lds
    buffer_load_dwordx4 v[204:207], v7, s[36:39], s41 offen
    s_add_u32 s41, s41, 2048
    buffer_load_dwordx4 v5, s[20:23], s40 offen offset:1024 lds
    s_add_u32 s40, s40, 57344
    s_lshr_b32 s34, s2, 3
    s_sub_u32 s34, 31, s34
    s_mul_i32 s30, s34, 9363
    s_lshr_b32 s30, s30, 16
    s_mul_i32 s31, s30, 7
    s_sub_u32 s31, s34, s31
    s_and_b32 s45, s2, 7
    s_lshl_b32 s45, s45, 2
    s_add_u32 s30, s30, s45
    s_mul_i32 s32, s16, 1835008
    s_lshl_b32 s45, s30, 7
    s_add_u32 s32, s32, s45
    s_mul_i32 s33, s31, 229376
    s_mul_i32 s46, s16, 57344
    s_add_u32 s33, s33, s46
    s_add_u32 s33, s33, 4259840
    s_mul_i32 s48, s16, 100352
    s_lshl_b32 s46, s31, 7
    s_add_u32 s48, s48, s46
    s_lshl_b32 s49, s30, 16
    s_lshl_b32 s46, s16, 14
    s_add_u32 s49, s49, s46
    s_add_u32 s49, s49, 6291456
    s_lshl_b32 s52, s31, 2
    s_add_u32 s52, s52, s16
    s_mul_i32 s52, s52, 896
    s_add_u32 s52, s52, 5898240
    s_lshl_b32 s53, s30, 3
    s_add_u32 s53, s53, s16
    s_lshl_b32 s53, s53, 7
    s_add_u32 s53, s53, 5931008
    s_lshl_b32 s46, s42, 10
    v_add_u32 v28, s46, v2
    v_xor_b32 v29, 1024, v28
    v_lshrrev_b32 v3, 3, v1
    s_mov_b32 s47, 4096
    v_mul_lo_u32 v214, v3, s47
    v_lshlrev_b32 v3, 1, v3
    v_and_b32 v3, 4, v3
    v_xor_b32 v3, v3, v1
    v_and_b32 v3, 7, v3
    v_lshl_add_u32 v214, v3, 4, v214
    v_add_u32 v215, 31744, v214
    s_mov_b32 s84, s8
    s_mov_b32 s85, s9
    s_mov_b32 s86, 7340032
    s_mov_b32 s87, 0x20000
    s_mov_b32 s24, s10
    s_mov_b32 s25, s11
    s_mov_b32 s26, 4096
    s_mov_b32 s27, 0x20000
    s_cmp_lt_u32 s34, 28
    s_cselect_b32 s86, s86, 0
    v_and_b32 v3, 31, v1
    s_lshl_b32 s46, s43, 5
    v_add_u32 v213, s46, v3
    v_lshlrev_b32 v208, 2, v213
    v_xor_b32 v209, 128, v208
    v_lshlrev_b32 v212, 1, v213
    s_lshl_b32 s46, s30, 8
    s_add_u32 s46, s46, 4194304
    buffer_load_dword v208, v208, s[36:39], s46 offen
    buffer_load_dword v209, v209, s[36:39], s46 offen
    buffer_load_ushort v212, v212, s[24:27], s45 offen
    v_lshrrev_b32 v3, 5, v1
    v_lshlrev_b32 v26, 9, v3
    v_bfe_u32 v3, v1, 2, 2
    v_lshl_add_u32 v26, v3, 7, v26
    v_lshrrev_b32 v3, 1, v3
    v_xor_b32 v3, s43, v3
    v_lshl_add_u32 v26, v3, 6, v26
    v_bfe_u32 v3, v1, 4, 1
    v_lshl_add_u32 v26, v3, 5, v26
    v_and_b32 v3, 3, v1
    v_lshl_add_u32 v26, v3, 3, v26
    v_add_u32 v26, s44, v26
    v_xor_b32 v27, 64, v26
    v_lshrrev_b32 v3, 3, v1
    s_mov_b32 s47, 896
    v_mul_lo_u32 v30, v3, s47
    v_lshlrev_b32 v3, 1, v3
    v_and_b32 v3, 4, v3
    v_xor_b32 v3, v3, v1
    v_and_b32 v3, 7, v3
    v_lshl_add_u32 v30, v3, 4, v30
    v_add_u32 v31, 6144, v30
    s_waitcnt vmcnt(44)
    ds_read_b64_tr_b16 v[96:97], v12 offset:0
    ds_read_b64_tr_b16 v[98:99], v12 offset:1024
    ds_read_b64_tr_b16 v[100:101], v13 offset:0
    ds_read_b64_tr_b16 v[102:103], v13 offset:1024
    s_waitcnt vmcnt(40)
    ds_read_b64_tr_b16 v[104:105], v12 offset:2048
    ds_read_b64_tr_b16 v[106:107], v12 offset:3072
    ds_read_b64_tr_b16 v[108:109], v13 offset:2048
    ds_read_b64_tr_b16 v[110:111], v13 offset:3072
    s_waitcnt lgkmcnt(4)
    v_mfma_f32_32x32x16_bf16 v[32:47], v[96:99], v[112:115], 0
    v_mfma_f32_32x32x16_bf16 v[48:63], v[96:99], v[116:119], 0
    v_mfma_f32_32x32x16_bf16 v[64:79], v[100:103], v[112:115], 0
    v_mfma_f32_32x32x16_bf16 v[80:95], v[100:103], v[116:119], 0
    s_add_u32 m0, s44, 0
    buffer_load_dwordx4 v[112:115], v6, s[36:39], s41 offen
    buffer_load_dwordx4 v4, s[20:23], s40 offen lds
    buffer_load_dwordx4 v[116:119], v7, s[36:39], s41 offen
    s_add_u32 s41, s41, 2048
    buffer_load_dwordx4 v5, s[20:23], s40 offen offset:1024 lds
    s_add_u32 s40, s40, 57344
    s_waitcnt vmcnt(40)
    ds_read_b64_tr_b16 v[96:97], v12 offset:4096
    ds_read_b64_tr_b16 v[98:99], v12 offset:5120
    ds_read_b64_tr_b16 v[100:101], v13 offset:4096
    ds_read_b64_tr_b16 v[102:103], v13 offset:5120
    s_waitcnt lgkmcnt(4)
    v_mfma_f32_32x32x16_bf16 v[32:47], v[104:107], v[120:123], v[32:47]
    v_mfma_f32_32x32x16_bf16 v[48:63], v[104:107], v[124:127], v[48:63]
    v_mfma_f32_32x32x16_bf16 v[64:79], v[108:111], v[120:123], v[64:79]
    v_mfma_f32_32x32x16_bf16 v[80:95], v[108:111], v[124:127], v[80:95]
    s_add_u32 m0, s44, 2048
    buffer_load_dwordx4 v[120:123], v6, s[36:39], s41 offen
    buffer_load_dwordx4 v4, s[20:23], s40 offen lds
    buffer_load_dwordx4 v[124:127], v7, s[36:39], s41 offen
    s_add_u32 s41, s41, 2048
    buffer_load_dwordx4 v5, s[20:23], s40 offen offset:1024 lds
    s_add_u32 s40, s40, 57344
    s_waitcnt vmcnt(40)
    ds_read_b64_tr_b16 v[104:105], v12 offset:6144
    ds_read_b64_tr_b16 v[106:107], v12 offset:7168
    ds_read_b64_tr_b16 v[108:109], v13 offset:6144
    ds_read_b64_tr_b16 v[110:111], v13 offset:7168
    s_waitcnt lgkmcnt(4)
    v_mfma_f32_32x32x16_bf16 v[32:47], v[96:99], v[128:131], v[32:47]
    v_mfma_f32_32x32x16_bf16 v[48:63], v[96:99], v[132:135], v[48:63]
    v_mfma_f32_32x32x16_bf16 v[64:79], v[100:103], v[128:131], v[64:79]
    v_mfma_f32_32x32x16_bf16 v[80:95], v[100:103], v[132:135], v[80:95]
    s_add_u32 m0, s44, 4096
    buffer_load_dwordx4 v[128:131], v6, s[36:39], s41 offen
    buffer_load_dwordx4 v4, s[20:23], s40 offen lds
    buffer_load_dwordx4 v[132:135], v7, s[36:39], s41 offen
    s_add_u32 s41, s41, 2048
    buffer_load_dwordx4 v5, s[20:23], s40 offen offset:1024 lds
    s_add_u32 s40, s40, 57344
    s_waitcnt vmcnt(40)
    ds_read_b64_tr_b16 v[96:97], v12 offset:8192
    ds_read_b64_tr_b16 v[98:99], v12 offset:9216
    ds_read_b64_tr_b16 v[100:101], v13 offset:8192
    ds_read_b64_tr_b16 v[102:103], v13 offset:9216
    s_waitcnt lgkmcnt(4)
    v_mfma_f32_32x32x16_bf16 v[32:47], v[104:107], v[136:139], v[32:47]
    v_mfma_f32_32x32x16_bf16 v[48:63], v[104:107], v[140:143], v[48:63]
    v_mfma_f32_32x32x16_bf16 v[64:79], v[108:111], v[136:139], v[64:79]
    v_mfma_f32_32x32x16_bf16 v[80:95], v[108:111], v[140:143], v[80:95]
    s_waitcnt vmcnt(36)
    ds_read_b64_tr_b16 v[104:105], v12 offset:10240
    ds_read_b64_tr_b16 v[106:107], v12 offset:11264
    ds_read_b64_tr_b16 v[108:109], v13 offset:10240
    ds_read_b64_tr_b16 v[110:111], v13 offset:11264
    s_waitcnt lgkmcnt(4)
    v_mfma_f32_32x32x16_bf16 v[32:47], v[96:99], v[144:147], v[32:47]
    v_mfma_f32_32x32x16_bf16 v[48:63], v[96:99], v[148:151], v[48:63]
    v_mfma_f32_32x32x16_bf16 v[64:79], v[100:103], v[144:147], v[64:79]
    v_mfma_f32_32x32x16_bf16 v[80:95], v[100:103], v[148:151], v[80:95]
    s_add_u32 m0, s44, 6144
    buffer_load_dwordx4 v[136:139], v6, s[36:39], s41 offen
    buffer_load_dwordx4 v4, s[20:23], s40 offen lds
    buffer_load_dwordx4 v[140:143], v7, s[36:39], s41 offen
    s_add_u32 s41, s41, 2048
    buffer_load_dwordx4 v5, s[20:23], s40 offen offset:1024 lds
    s_add_u32 s40, s40, 57344
    s_waitcnt vmcnt(36)
    ds_read_b64_tr_b16 v[96:97], v12 offset:12288
    ds_read_b64_tr_b16 v[98:99], v12 offset:13312
    ds_read_b64_tr_b16 v[100:101], v13 offset:12288
    ds_read_b64_tr_b16 v[102:103], v13 offset:13312
    s_waitcnt lgkmcnt(4)
    v_mfma_f32_32x32x16_bf16 v[32:47], v[104:107], v[152:155], v[32:47]
    v_mfma_f32_32x32x16_bf16 v[48:63], v[104:107], v[156:159], v[48:63]
    v_mfma_f32_32x32x16_bf16 v[64:79], v[108:111], v[152:155], v[64:79]
    v_mfma_f32_32x32x16_bf16 v[80:95], v[108:111], v[156:159], v[80:95]
    s_add_u32 m0, s44, 8192
    buffer_load_dwordx4 v[144:147], v6, s[36:39], s41 offen
    buffer_load_dwordx4 v4, s[20:23], s40 offen lds
    buffer_load_dwordx4 v[148:151], v7, s[36:39], s41 offen
    s_add_u32 s41, s41, 2048
    buffer_load_dwordx4 v5, s[20:23], s40 offen offset:1024 lds
    s_add_u32 s40, s40, 57344
    s_waitcnt vmcnt(36)
    ds_read_b64_tr_b16 v[104:105], v12 offset:14336
    ds_read_b64_tr_b16 v[106:107], v12 offset:15360
    ds_read_b64_tr_b16 v[108:109], v13 offset:14336
    ds_read_b64_tr_b16 v[110:111], v13 offset:15360
    s_waitcnt lgkmcnt(4)
    v_mfma_f32_32x32x16_bf16 v[32:47], v[96:99], v[160:163], v[32:47]
    v_mfma_f32_32x32x16_bf16 v[48:63], v[96:99], v[164:167], v[48:63]
    v_mfma_f32_32x32x16_bf16 v[64:79], v[100:103], v[160:163], v[64:79]
    v_mfma_f32_32x32x16_bf16 v[80:95], v[100:103], v[164:167], v[80:95]
    s_waitcnt vmcnt(32)
    ds_read_b64_tr_b16 v[96:97], v12 offset:16384
    ds_read_b64_tr_b16 v[98:99], v12 offset:17408
    ds_read_b64_tr_b16 v[100:101], v13 offset:16384
    ds_read_b64_tr_b16 v[102:103], v13 offset:17408
    s_waitcnt lgkmcnt(4)
    v_mfma_f32_32x32x16_bf16 v[32:47], v[104:107], v[168:171], v[32:47]
    v_mfma_f32_32x32x16_bf16 v[48:63], v[104:107], v[172:175], v[48:63]
    v_mfma_f32_32x32x16_bf16 v[64:79], v[108:111], v[168:171], v[64:79]
    v_mfma_f32_32x32x16_bf16 v[80:95], v[108:111], v[172:175], v[80:95]
    s_add_u32 m0, s44, 10240
    buffer_load_dwordx4 v[152:155], v6, s[36:39], s41 offen
    buffer_load_dwordx4 v4, s[20:23], s40 offen lds
    buffer_load_dwordx4 v[156:159], v7, s[36:39], s41 offen
    s_add_u32 s41, s41, 2048
    buffer_load_dwordx4 v5, s[20:23], s40 offen offset:1024 lds
    s_add_u32 s40, s40, 57344
    s_waitcnt vmcnt(32)
    ds_read_b64_tr_b16 v[104:105], v12 offset:18432
    ds_read_b64_tr_b16 v[106:107], v12 offset:19456
    ds_read_b64_tr_b16 v[108:109], v13 offset:18432
    ds_read_b64_tr_b16 v[110:111], v13 offset:19456
    s_waitcnt lgkmcnt(4)
    v_mfma_f32_32x32x16_bf16 v[32:47], v[96:99], v[176:179], v[32:47]
    v_mfma_f32_32x32x16_bf16 v[48:63], v[96:99], v[180:183], v[48:63]
    v_mfma_f32_32x32x16_bf16 v[64:79], v[100:103], v[176:179], v[64:79]
    v_mfma_f32_32x32x16_bf16 v[80:95], v[100:103], v[180:183], v[80:95]
    s_add_u32 m0, s44, 12288
    buffer_load_dwordx4 v[160:163], v6, s[36:39], s41 offen
    buffer_load_dwordx4 v4, s[20:23], s40 offen lds
    buffer_load_dwordx4 v[164:167], v7, s[36:39], s41 offen
    s_add_u32 s41, s41, 2048
    buffer_load_dwordx4 v5, s[20:23], s40 offen offset:1024 lds
    s_add_u32 s40, s40, 57344
    s_waitcnt vmcnt(32)
    ds_read_b64_tr_b16 v[96:97], v12 offset:20480
    ds_read_b64_tr_b16 v[98:99], v12 offset:21504
    ds_read_b64_tr_b16 v[100:101], v13 offset:20480
    ds_read_b64_tr_b16 v[102:103], v13 offset:21504
    s_waitcnt lgkmcnt(4)
    v_mfma_f32_32x32x16_bf16 v[32:47], v[104:107], v[184:187], v[32:47]
    v_mfma_f32_32x32x16_bf16 v[48:63], v[104:107], v[188:191], v[48:63]
    v_mfma_f32_32x32x16_bf16 v[64:79], v[108:111], v[184:187], v[64:79]
    v_mfma_f32_32x32x16_bf16 v[80:95], v[108:111], v[188:191], v[80:95]
    s_waitcnt vmcnt(28)
    ds_read_b64_tr_b16 v[104:105], v12 offset:22528
    ds_read_b64_tr_b16 v[106:107], v12 offset:23552
    ds_read_b64_tr_b16 v[108:109], v13 offset:22528
    ds_read_b64_tr_b16 v[110:111], v13 offset:23552
    s_waitcnt lgkmcnt(4)
    v_mfma_f32_32x32x16_bf16 v[32:47], v[96:99], v[192:195], v[32:47]
    v_mfma_f32_32x32x16_bf16 v[48:63], v[96:99], v[196:199], v[48:63]
    v_mfma_f32_32x32x16_bf16 v[64:79], v[100:103], v[192:195], v[64:79]
    v_mfma_f32_32x32x16_bf16 v[80:95], v[100:103], v[196:199], v[80:95]
    s_add_u32 m0, s44, 14336
    buffer_load_dwordx4 v[168:171], v6, s[36:39], s41 offen
    buffer_load_dwordx4 v4, s[20:23], s40 offen lds
    buffer_load_dwordx4 v[172:175], v7, s[36:39], s41 offen
    s_add_u32 s41, s41, 2048
    buffer_load_dwordx4 v5, s[20:23], s40 offen offset:1024 lds
    s_add_u32 s40, s40, 57344
    s_waitcnt vmcnt(28)
    ds_read_b64_tr_b16 v[96:97], v12 offset:0
    ds_read_b64_tr_b16 v[98:99], v12 offset:1024
    ds_read_b64_tr_b16 v[100:101], v13 offset:0
    ds_read_b64_tr_b16 v[102:103], v13 offset:1024
    s_waitcnt lgkmcnt(4)
    v_mfma_f32_32x32x16_bf16 v[32:47], v[104:107], v[200:203], v[32:47]
    v_mfma_f32_32x32x16_bf16 v[48:63], v[104:107], v[204:207], v[48:63]
    v_mfma_f32_32x32x16_bf16 v[64:79], v[108:111], v[200:203], v[64:79]
    v_mfma_f32_32x32x16_bf16 v[80:95], v[108:111], v[204:207], v[80:95]
    s_add_u32 m0, s44, 16384
    buffer_load_dwordx4 v[176:179], v6, s[36:39], s41 offen
    buffer_load_dwordx4 v4, s[20:23], s40 offen lds
    buffer_load_dwordx4 v[180:183], v7, s[36:39], s41 offen
    s_add_u32 s41, s41, 2048
    buffer_load_dwordx4 v5, s[20:23], s40 offen offset:1024 lds
    s_add_u32 s40, s40, 57344
    s_waitcnt vmcnt(28)
    ds_read_b64_tr_b16 v[104:105], v12 offset:2048
    ds_read_b64_tr_b16 v[106:107], v12 offset:3072
    ds_read_b64_tr_b16 v[108:109], v13 offset:2048
    ds_read_b64_tr_b16 v[110:111], v13 offset:3072
    s_waitcnt lgkmcnt(4)
    v_mfma_f32_32x32x16_bf16 v[32:47], v[96:99], v[112:115], v[32:47]
    v_mfma_f32_32x32x16_bf16 v[48:63], v[96:99], v[116:119], v[48:63]
    v_mfma_f32_32x32x16_bf16 v[64:79], v[100:103], v[112:115], v[64:79]
    v_mfma_f32_32x32x16_bf16 v[80:95], v[100:103], v[116:119], v[80:95]
    s_waitcnt vmcnt(24)
    ds_read_b64_tr_b16 v[96:97], v12 offset:4096
    ds_read_b64_tr_b16 v[98:99], v12 offset:5120
    ds_read_b64_tr_b16 v[100:101], v13 offset:4096
    ds_read_b64_tr_b16 v[102:103], v13 offset:5120
    s_waitcnt lgkmcnt(4)
    v_mfma_f32_32x32x16_bf16 v[32:47], v[104:107], v[120:123], v[32:47]
    v_mfma_f32_32x32x16_bf16 v[48:63], v[104:107], v[124:127], v[48:63]
    v_mfma_f32_32x32x16_bf16 v[64:79], v[108:111], v[120:123], v[64:79]
    v_mfma_f32_32x32x16_bf16 v[80:95], v[108:111], v[124:127], v[80:95]
    s_add_u32 m0, s44, 18432
    buffer_load_dwordx4 v[184:187], v6, s[36:39], s41 offen
    buffer_load_dwordx4 v4, s[20:23], s40 offen lds
    buffer_load_dwordx4 v[188:191], v7, s[36:39], s41 offen
    s_add_u32 s41, s41, 2048
    buffer_load_dwordx4 v5, s[20:23], s40 offen offset:1024 lds
    s_add_u32 s40, s40, 57344
    s_waitcnt vmcnt(24)
    ds_read_b64_tr_b16 v[104:105], v12 offset:6144
    ds_read_b64_tr_b16 v[106:107], v12 offset:7168
    ds_read_b64_tr_b16 v[108:109], v13 offset:6144
    ds_read_b64_tr_b16 v[110:111], v13 offset:7168
    s_waitcnt lgkmcnt(4)
    v_mfma_f32_32x32x16_bf16 v[32:47], v[96:99], v[128:131], v[32:47]
    v_mfma_f32_32x32x16_bf16 v[48:63], v[96:99], v[132:135], v[48:63]
    v_mfma_f32_32x32x16_bf16 v[64:79], v[100:103], v[128:131], v[64:79]
    v_mfma_f32_32x32x16_bf16 v[80:95], v[100:103], v[132:135], v[80:95]
    s_add_u32 m0, s44, 20480
    buffer_load_dwordx4 v[192:195], v6, s[36:39], s41 offen
    buffer_load_dwordx4 v4, s[20:23], s40 offen lds
    buffer_load_dwordx4 v[196:199], v7, s[36:39], s41 offen
    s_add_u32 s41, s41, 2048
    buffer_load_dwordx4 v5, s[20:23], s40 offen offset:1024 lds
    s_add_u32 s40, s40, 57344
    s_waitcnt vmcnt(24)
    ds_read_b64_tr_b16 v[96:97], v12 offset:8192
    ds_read_b64_tr_b16 v[98:99], v12 offset:9216
    ds_read_b64_tr_b16 v[100:101], v13 offset:8192
    ds_read_b64_tr_b16 v[102:103], v13 offset:9216
    s_waitcnt lgkmcnt(4)
    v_mfma_f32_32x32x16_bf16 v[32:47], v[104:107], v[136:139], v[32:47]
    v_mfma_f32_32x32x16_bf16 v[48:63], v[104:107], v[140:143], v[48:63]
    v_mfma_f32_32x32x16_bf16 v[64:79], v[108:111], v[136:139], v[64:79]
    v_mfma_f32_32x32x16_bf16 v[80:95], v[108:111], v[140:143], v[80:95]
    s_waitcnt vmcnt(20)
    ds_read_b64_tr_b16 v[104:105], v12 offset:10240
    ds_read_b64_tr_b16 v[106:107], v12 offset:11264
    ds_read_b64_tr_b16 v[108:109], v13 offset:10240
    ds_read_b64_tr_b16 v[110:111], v13 offset:11264
    s_waitcnt lgkmcnt(4)
    v_mfma_f32_32x32x16_bf16 v[32:47], v[96:99], v[144:147], v[32:47]
    v_mfma_f32_32x32x16_bf16 v[48:63], v[96:99], v[148:151], v[48:63]
    v_mfma_f32_32x32x16_bf16 v[64:79], v[100:103], v[144:147], v[64:79]
    v_mfma_f32_32x32x16_bf16 v[80:95], v[100:103], v[148:151], v[80:95]
    s_add_u32 m0, s44, 22528
    buffer_load_dwordx4 v[200:203], v6, s[36:39], s41 offen
    buffer_load_dwordx4 v4, s[20:23], s40 offen lds
    buffer_load_dwordx4 v[204:207], v7, s[36:39], s41 offen
    s_add_u32 s41, s41, 2048
    buffer_load_dwordx4 v5, s[20:23], s40 offen offset:1024 lds
    s_add_u32 s40, s40, 57344
    s_waitcnt vmcnt(20)
    ds_read_b64_tr_b16 v[96:97], v12 offset:12288
    ds_read_b64_tr_b16 v[98:99], v12 offset:13312
    ds_read_b64_tr_b16 v[100:101], v13 offset:12288
    ds_read_b64_tr_b16 v[102:103], v13 offset:13312
    s_waitcnt lgkmcnt(4)
    v_mfma_f32_32x32x16_bf16 v[32:47], v[104:107], v[152:155], v[32:47]
    v_mfma_f32_32x32x16_bf16 v[48:63], v[104:107], v[156:159], v[48:63]
    v_mfma_f32_32x32x16_bf16 v[64:79], v[108:111], v[152:155], v[64:79]
    v_mfma_f32_32x32x16_bf16 v[80:95], v[108:111], v[156:159], v[80:95]
    s_add_u32 m0, s44, 0
    buffer_load_dwordx4 v[112:115], v6, s[36:39], s41 offen
    buffer_load_dwordx4 v4, s[20:23], s40 offen lds
    buffer_load_dwordx4 v[116:119], v7, s[36:39], s41 offen
    s_add_u32 s41, s41, 2048
    buffer_load_dwordx4 v5, s[20:23], s40 offen offset:1024 lds
    s_add_u32 s40, s40, 57344
    s_waitcnt vmcnt(20)
    ds_read_b64_tr_b16 v[104:105], v12 offset:14336
    ds_read_b64_tr_b16 v[106:107], v12 offset:15360
    ds_read_b64_tr_b16 v[108:109], v13 offset:14336
    ds_read_b64_tr_b16 v[110:111], v13 offset:15360
    s_waitcnt lgkmcnt(4)
    v_mfma_f32_32x32x16_bf16 v[32:47], v[96:99], v[160:163], v[32:47]
    v_mfma_f32_32x32x16_bf16 v[48:63], v[96:99], v[164:167], v[48:63]
    v_mfma_f32_32x32x16_bf16 v[64:79], v[100:103], v[160:163], v[64:79]
    v_mfma_f32_32x32x16_bf16 v[80:95], v[100:103], v[164:167], v[80:95]
    s_waitcnt vmcnt(16)
    ds_read_b64_tr_b16 v[96:97], v12 offset:16384
    ds_read_b64_tr_b16 v[98:99], v12 offset:17408
    ds_read_b64_tr_b16 v[100:101], v13 offset:16384
    ds_read_b64_tr_b16 v[102:103], v13 offset:17408
    s_waitcnt lgkmcnt(4)
    v_mfma_f32_32x32x16_bf16 v[32:47], v[104:107], v[168:171], v[32:47]
    v_mfma_f32_32x32x16_bf16 v[48:63], v[104:107], v[172:175], v[48:63]
    v_mfma_f32_32x32x16_bf16 v[64:79], v[108:111], v[168:171], v[64:79]
    v_mfma_f32_32x32x16_bf16 v[80:95], v[108:111], v[172:175], v[80:95]
    s_add_u32 m0, s44, 2048
    buffer_load_dwordx4 v[120:123], v6, s[36:39], s41 offen
    buffer_load_dwordx4 v4, s[20:23], s40 offen lds
    buffer_load_dwordx4 v[124:127], v7, s[36:39], s41 offen
    s_add_u32 s41, s41, 2048
    buffer_load_dwordx4 v5, s[20:23], s40 offen offset:1024 lds
    s_add_u32 s40, s40, 57344
    s_waitcnt vmcnt(16)
    ds_read_b64_tr_b16 v[104:105], v12 offset:18432
    ds_read_b64_tr_b16 v[106:107], v12 offset:19456
    ds_read_b64_tr_b16 v[108:109], v13 offset:18432
    ds_read_b64_tr_b16 v[110:111], v13 offset:19456
    s_waitcnt lgkmcnt(4)
    v_mfma_f32_32x32x16_bf16 v[32:47], v[96:99], v[176:179], v[32:47]
    v_mfma_f32_32x32x16_bf16 v[48:63], v[96:99], v[180:183], v[48:63]
    v_mfma_f32_32x32x16_bf16 v[64:79], v[100:103], v[176:179], v[64:79]
    v_mfma_f32_32x32x16_bf16 v[80:95], v[100:103], v[180:183], v[80:95]
    s_add_u32 m0, s44, 4096
    buffer_load_dwordx4 v[128:131], v6, s[36:39], s41 offen
    buffer_load_dwordx4 v4, s[20:23], s40 offen lds
    buffer_load_dwordx4 v[132:135], v7, s[36:39], s41 offen
    s_add_u32 s41, s41, 2048
    buffer_load_dwordx4 v5, s[20:23], s40 offen offset:1024 lds
    s_add_u32 s40, s40, 57344
    s_waitcnt vmcnt(16)
    ds_read_b64_tr_b16 v[96:97], v12 offset:20480
    ds_read_b64_tr_b16 v[98:99], v12 offset:21504
    ds_read_b64_tr_b16 v[100:101], v13 offset:20480
    ds_read_b64_tr_b16 v[102:103], v13 offset:21504
    s_waitcnt lgkmcnt(4)
    v_mfma_f32_32x32x16_bf16 v[32:47], v[104:107], v[184:187], v[32:47]
    v_mfma_f32_32x32x16_bf16 v[48:63], v[104:107], v[188:191], v[48:63]
    v_mfma_f32_32x32x16_bf16 v[64:79], v[108:111], v[184:187], v[64:79]
    v_mfma_f32_32x32x16_bf16 v[80:95], v[108:111], v[188:191], v[80:95]
    s_add_u32 m0, s44, 6144
    buffer_load_dwordx4 v[136:139], v6, s[36:39], s41 offen
    buffer_load_dwordx4 v4, s[20:23], s40 offen lds
    buffer_load_dwordx4 v[140:143], v7, s[36:39], s41 offen
    s_add_u32 s41, s41, 2048
    buffer_load_dwordx4 v5, s[20:23], s40 offen offset:1024 lds
    s_add_u32 s40, s40, 57344
    s_waitcnt vmcnt(16)
    ds_read_b64_tr_b16 v[104:105], v12 offset:22528
    ds_read_b64_tr_b16 v[106:107], v12 offset:23552
    ds_read_b64_tr_b16 v[108:109], v13 offset:22528
    ds_read_b64_tr_b16 v[110:111], v13 offset:23552
    s_waitcnt lgkmcnt(4)
    v_mfma_f32_32x32x16_bf16 v[32:47], v[96:99], v[192:195], v[32:47]
    v_mfma_f32_32x32x16_bf16 v[48:63], v[96:99], v[196:199], v[48:63]
    v_mfma_f32_32x32x16_bf16 v[64:79], v[100:103], v[192:195], v[64:79]
    v_mfma_f32_32x32x16_bf16 v[80:95], v[100:103], v[196:199], v[80:95]
    s_add_u32 m0, s44, 8192
    buffer_load_dwordx4 v[144:147], v6, s[36:39], s41 offen
    buffer_load_dwordx4 v4, s[20:23], s40 offen lds
    buffer_load_dwordx4 v[148:151], v7, s[36:39], s41 offen
    s_add_u32 s41, s41, 2048
    buffer_load_dwordx4 v5, s[20:23], s40 offen offset:1024 lds
    s_add_u32 s40, s40, 57344
    s_waitcnt vmcnt(16)
    ds_read_b64_tr_b16 v[96:97], v12 offset:0
    ds_read_b64_tr_b16 v[98:99], v12 offset:1024
    ds_read_b64_tr_b16 v[100:101], v13 offset:0
    ds_read_b64_tr_b16 v[102:103], v13 offset:1024
    s_waitcnt lgkmcnt(4)
    v_mfma_f32_32x32x16_bf16 v[32:47], v[104:107], v[200:203], v[32:47]
    v_mfma_f32_32x32x16_bf16 v[48:63], v[104:107], v[204:207], v[48:63]
    v_mfma_f32_32x32x16_bf16 v[64:79], v[108:111], v[200:203], v[64:79]
    v_mfma_f32_32x32x16_bf16 v[80:95], v[108:111], v[204:207], v[80:95]
    s_add_u32 m0, s44, 10240
    buffer_load_dwordx4 v[152:155], v6, s[36:39], s41 offen
    buffer_load_dwordx4 v4, s[20:23], s40 offen lds
    buffer_load_dwordx4 v[156:159], v7, s[36:39], s41 offen
    s_add_u32 s41, s41, 2048
    buffer_load_dwordx4 v5, s[20:23], s40 offen offset:1024 lds
    s_add_u32 s40, s40, 57344
    s_waitcnt vmcnt(16)
    ds_read_b64_tr_b16 v[104:105], v12 offset:2048
    ds_read_b64_tr_b16 v[106:107], v12 offset:3072
    ds_read_b64_tr_b16 v[108:109], v13 offset:2048
    ds_read_b64_tr_b16 v[110:111], v13 offset:3072
    s_waitcnt lgkmcnt(4)
    v_mfma_f32_32x32x16_bf16 v[32:47], v[96:99], v[112:115], v[32:47]
    v_mfma_f32_32x32x16_bf16 v[48:63], v[96:99], v[116:119], v[48:63]
    v_mfma_f32_32x32x16_bf16 v[64:79], v[100:103], v[112:115], v[64:79]
    v_mfma_f32_32x32x16_bf16 v[80:95], v[100:103], v[116:119], v[80:95]
    s_add_u32 m0, s44, 12288
    buffer_load_dwordx4 v[160:163], v6, s[36:39], s41 offen
    buffer_load_dwordx4 v4, s[20:23], s40 offen lds
    buffer_load_dwordx4 v[164:167], v7, s[36:39], s41 offen
    s_add_u32 s41, s41, 2048
    buffer_load_dwordx4 v5, s[20:23], s40 offen offset:1024 lds
    s_add_u32 s40, s40, 57344
    s_waitcnt vmcnt(16)
    ds_read_b64_tr_b16 v[96:97], v12 offset:4096
    ds_read_b64_tr_b16 v[98:99], v12 offset:5120
    ds_read_b64_tr_b16 v[100:101], v13 offset:4096
    ds_read_b64_tr_b16 v[102:103], v13 offset:5120
    s_waitcnt lgkmcnt(4)
    v_mfma_f32_32x32x16_bf16 v[32:47], v[104:107], v[120:123], v[32:47]
    v_mfma_f32_32x32x16_bf16 v[48:63], v[104:107], v[124:127], v[48:63]
    v_mfma_f32_32x32x16_bf16 v[64:79], v[108:111], v[120:123], v[64:79]
    v_mfma_f32_32x32x16_bf16 v[80:95], v[108:111], v[124:127], v[80:95]
    s_add_u32 m0, s44, 14336
    buffer_load_dwordx4 v[168:171], v6, s[36:39], s41 offen
    buffer_load_dwordx4 v4, s[20:23], s40 offen lds
    buffer_load_dwordx4 v[172:175], v7, s[36:39], s41 offen
    s_add_u32 s41, s41, 2048
    buffer_load_dwordx4 v5, s[20:23], s40 offen offset:1024 lds
    s_add_u32 s40, s40, 57344
    s_waitcnt vmcnt(16)
    ds_read_b64_tr_b16 v[104:105], v12 offset:6144
    ds_read_b64_tr_b16 v[106:107], v12 offset:7168
    ds_read_b64_tr_b16 v[108:109], v13 offset:6144
    ds_read_b64_tr_b16 v[110:111], v13 offset:7168
    s_waitcnt lgkmcnt(4)
    v_mfma_f32_32x32x16_bf16 v[32:47], v[96:99], v[128:131], v[32:47]
    v_mfma_f32_32x32x16_bf16 v[48:63], v[96:99], v[132:135], v[48:63]
    v_mfma_f32_32x32x16_bf16 v[64:79], v[100:103], v[128:131], v[64:79]
    v_mfma_f32_32x32x16_bf16 v[80:95], v[100:103], v[132:135], v[80:95]
    s_waitcnt vmcnt(12)
    ds_read_b64_tr_b16 v[96:97], v12 offset:8192
    ds_read_b64_tr_b16 v[98:99], v12 offset:9216
    ds_read_b64_tr_b16 v[100:101], v13 offset:8192
    ds_read_b64_tr_b16 v[102:103], v13 offset:9216
    s_waitcnt lgkmcnt(4)
    v_mfma_f32_32x32x16_bf16 v[32:47], v[104:107], v[136:139], v[32:47]
    v_mfma_f32_32x32x16_bf16 v[48:63], v[104:107], v[140:143], v[48:63]
    v_mfma_f32_32x32x16_bf16 v[64:79], v[108:111], v[136:139], v[64:79]
    v_mfma_f32_32x32x16_bf16 v[80:95], v[108:111], v[140:143], v[80:95]
    s_waitcnt vmcnt(8)
    ds_read_b64_tr_b16 v[104:105], v12 offset:10240
    ds_read_b64_tr_b16 v[106:107], v12 offset:11264
    ds_read_b64_tr_b16 v[108:109], v13 offset:10240
    ds_read_b64_tr_b16 v[110:111], v13 offset:11264
    s_waitcnt lgkmcnt(4)
    v_mfma_f32_32x32x16_bf16 v[32:47], v[96:99], v[144:147], v[32:47]
    v_mfma_f32_32x32x16_bf16 v[48:63], v[96:99], v[148:151], v[48:63]
    v_mfma_f32_32x32x16_bf16 v[64:79], v[100:103], v[144:147], v[64:79]
    v_mfma_f32_32x32x16_bf16 v[80:95], v[100:103], v[148:151], v[80:95]
    s_waitcnt vmcnt(4)
    ds_read_b64_tr_b16 v[96:97], v12 offset:12288
    ds_read_b64_tr_b16 v[98:99], v12 offset:13312
    ds_read_b64_tr_b16 v[100:101], v13 offset:12288
    ds_read_b64_tr_b16 v[102:103], v13 offset:13312
    s_waitcnt lgkmcnt(4)
    v_mfma_f32_32x32x16_bf16 v[32:47], v[104:107], v[152:155], v[32:47]
    v_mfma_f32_32x32x16_bf16 v[48:63], v[104:107], v[156:159], v[48:63]
    v_mfma_f32_32x32x16_bf16 v[64:79], v[108:111], v[152:155], v[64:79]
    v_mfma_f32_32x32x16_bf16 v[80:95], v[108:111], v[156:159], v[80:95]
    s_waitcnt vmcnt(0)
    ds_read_b64_tr_b16 v[104:105], v12 offset:14336
    ds_read_b64_tr_b16 v[106:107], v12 offset:15360
    ds_read_b64_tr_b16 v[108:109], v13 offset:14336
    ds_read_b64_tr_b16 v[110:111], v13 offset:15360
    s_waitcnt lgkmcnt(4)
    v_mfma_f32_32x32x16_bf16 v[32:47], v[96:99], v[160:163], v[32:47]
    v_mfma_f32_32x32x16_bf16 v[48:63], v[96:99], v[164:167], v[48:63]
    v_mfma_f32_32x32x16_bf16 v[64:79], v[100:103], v[160:163], v[64:79]
    v_mfma_f32_32x32x16_bf16 v[80:95], v[100:103], v[164:167], v[80:95]
    s_waitcnt lgkmcnt(0)
    v_mfma_f32_32x32x16_bf16 v[32:47], v[104:107], v[168:171], v[32:47]
    v_mfma_f32_32x32x16_bf16 v[48:63], v[104:107], v[172:175], v[48:63]
    v_mfma_f32_32x32x16_bf16 v[64:79], v[108:111], v[168:171], v[64:79]
    v_mfma_f32_32x32x16_bf16 v[80:95], v[108:111], v[172:175], v[80:95]
    s_nop 7
    s_nop 4
    ds_write_b128 v8, v[48:51] offset:4096
    ds_write_b128 v8, v[52:55] offset:5120
    ds_write_b128 v8, v[56:59] offset:6144
    ds_write_b128 v8, v[60:63] offset:7168
    ds_write_b128 v8, v[64:67] offset:8192
    ds_write_b128 v8, v[68:71] offset:9216
    ds_write_b128 v8, v[72:75] offset:10240
    ds_write_b128 v8, v[76:79] offset:11264
    ds_write_b128 v8, v[80:83] offset:12288
    ds_write_b128 v8, v[84:87] offset:13312
    ds_write_b128 v8, v[88:91] offset:14336
    ds_write_b128 v8, v[92:95] offset:15360
    v_mov_b32 v25, 1
    s_waitcnt lgkmcnt(0)
    s_mov_b64 exec, 1
    ds_add_u32 v14, v25 offset:0
    s_mov_b64 exec, -1
LW3:
    ds_read_b32 v25, v14 offset:0
    s_waitcnt lgkmcnt(0)
    v_readfirstlane_b32 s54, v25
    s_cmp_lt_u32 s54, 4
    s_cbranch_scc1 LW3
    ds_read_b128 v[48:51], v9 offset:4096
    ds_read_b128 v[52:55], v9 offset:5120
    ds_read_b128 v[56:59], v9 offset:6144
    ds_read_b128 v[60:63], v9 offset:7168
    ds_read_b128 v[64:67], v10 offset:8192
    ds_read_b128 v[68:71], v10 offset:9216
    ds_read_b128 v[72:75], v10 offset:10240
    ds_read_b128 v[76:79], v10 offset:11264
    ds_read_b128 v[80:83], v11 offset:12288
    ds_read_b128 v[84:87], v11 offset:13312
    ds_read_b128 v[88:91], v11 offset:14336
    ds_read_b128 v[92:95], v11 offset:15360
    s_waitcnt lgkmcnt(8)
    v_pk_add_f32 v[32:33], v[32:33], v[48:49]
    v_pk_add_f32 v[34:35], v[34:35], v[50:51]
    v_pk_add_f32 v[36:37], v[36:37], v[52:53]
    v_pk_add_f32 v[38:39], v[38:39], v[54:55]
    v_pk_add_f32 v[40:41], v[40:41], v[56:57]
    v_pk_add_f32 v[42:43], v[42:43], v[58:59]
    v_pk_add_f32 v[44:45], v[44:45], v[60:61]
    v_pk_add_f32 v[46:47], v[46:47], v[62:63]
    s_waitcnt lgkmcnt(4)
    v_pk_add_f32 v[32:33], v[32:33], v[64:65]
    v_pk_add_f32 v[34:35], v[34:35], v[66:67]
    v_pk_add_f32 v[36:37], v[36:37], v[68:69]
    v_pk_add_f32 v[38:39], v[38:39], v[70:71]
    v_pk_add_f32 v[40:41], v[40:41], v[72:73]
    v_pk_add_f32 v[42:43], v[42:43], v[74:75]
    v_pk_add_f32 v[44:45], v[44:45], v[76:77]
    v_pk_add_f32 v[46:47], v[46:47], v[78:79]
    s_waitcnt lgkmcnt(0)
    v_pk_add_f32 v[32:33], v[32:33], v[80:81]
    v_pk_add_f32 v[34:35], v[34:35], v[82:83]
    v_pk_add_f32 v[36:37], v[36:37], v[84:85]
    v_pk_add_f32 v[38:39], v[38:39], v[86:87]
    v_pk_add_f32 v[40:41], v[40:41], v[88:89]
    v_pk_add_f32 v[42:43], v[42:43], v[90:91]
    v_pk_add_f32 v[44:45], v[44:45], v[92:93]
    v_pk_add_f32 v[46:47], v[46:47], v[94:95]
    v_mov_b32 v25, 1
    s_waitcnt lgkmcnt(0)
    s_mov_b64 exec, 1
    ds_add_u32 v14, v25 offset:4
    s_mov_b64 exec, -1
    s_mov_b32 s46, 0xbdd2d3e8
    v_mov_b32 v24, 0xc0135761
    s_mul_i32 s56, s19, 229376
    s_lshl_b32 s57, s18, 1
    s_add_u32 s57, s57, s42
    s_lshl_b32 s57, s57, 12
    s_add_u32 s56, s56, s57
    s_add_u32 s56, s56, 4259840
    s_mul_i32 s57, s19, 28
    s_add_u32 s57, s57, s18
    s_lshl_b32 s57, s57, 5
    s_add_u32 s57, s57, s16
    s_lshl_b32 s57, s57, 2
    s_add_u32 s57, s57, 5898240
    v_lshlrev_b32 v48, 16, v16
    v_and_b32 v49, 0xffff0000, v16
    v_lshlrev_b32 v50, 16, v17
    v_and_b32 v51, 0xffff0000, v17
    v_lshlrev_b32 v52, 16, v18
    v_and_b32 v53, 0xffff0000, v18
    v_lshlrev_b32 v54, 16, v19
    v_and_b32 v55, 0xffff0000, v19
    v_lshlrev_b32 v56, 16, v20
    v_and_b32 v57, 0xffff0000, v20
    v_lshlrev_b32 v58, 16, v21
    v_and_b32 v59, 0xffff0000, v21
    v_lshlrev_b32 v60, 16, v22
    v_and_b32 v61, 0xffff0000, v22
    v_lshlrev_b32 v62, 16, v23
    v_and_b32 v63, 0xffff0000, v23
    v_pk_add_f32 v[32:33], v[32:33], v[48:49]
    v_pk_add_f32 v[34:35], v[34:35], v[50:51]
    v_pk_add_f32 v[36:37], v[36:37], v[52:53]
    v_pk_add_f32 v[38:39], v[38:39], v[54:55]
    v_pk_add_f32 v[40:41], v[40:41], v[56:57]
    v_pk_add_f32 v[42:43], v[42:43], v[58:59]
    v_pk_add_f32 v[44:45], v[44:45], v[60:61]
    v_pk_add_f32 v[46:47], v[46:47], v[62:63]
    v_pk_mul_f32 v[48:49], v[32:33], v[32:33]
    v_pk_mul_f32 v[50:51], v[34:35], v[34:35]
    v_pk_mul_f32 v[52:53], v[36:37], v[36:37]
    v_pk_mul_f32 v[54:55], v[38:39], v[38:39]
    v_pk_mul_f32 v[56:57], v[40:41], v[40:41]
    v_pk_mul_f32 v[58:59], v[42:43], v[42:43]
    v_pk_mul_f32 v[60:61], v[44:45], v[44:45]
    v_pk_mul_f32 v[62:63], v[46:47], v[46:47]
    v_fma_f32 v48, v48, s46, v24
    v_fma_f32 v49, v49, s46, v24
    v_fma_f32 v50, v50, s46, v24
    v_fma_f32 v51, v51, s46, v24
    v_fma_f32 v52, v52, s46, v24
    v_fma_f32 v53, v53, s46, v24
    v_fma_f32 v54, v54, s46, v24
    v_fma_f32 v55, v55, s46, v24
    v_fma_f32 v56, v56, s46, v24
    v_fma_f32 v57, v57, s46, v24
    v_fma_f32 v58, v58, s46, v24
    v_fma_f32 v59, v59, s46, v24
    v_fma_f32 v60, v60, s46, v24
    v_fma_f32 v61, v61, s46, v24
    v_fma_f32 v62, v62, s46, v24
    v_fma_f32 v63, v63, s46, v24
    v_pk_mul_f32 v[48:49], v[48:49], v[32:33]
    v_pk_mul_f32 v[50:51], v[50:51], v[34:35]
    v_pk_mul_f32 v[52:53], v[52:53], v[36:37]
    v_pk_mul_f32 v[54:55], v[54:55], v[38:39]
    v_pk_mul_f32 v[56:57], v[56:57], v[40:41]
    v_pk_mul_f32 v[58:59], v[58:59], v[42:43]
    v_pk_mul_f32 v[60:61], v[60:61], v[44:45]
    v_pk_mul_f32 v[62:63], v[62:63], v[46:47]
    v_exp_f32 v48, v48
    v_exp_f32 v49, v49
    v_exp_f32 v50, v50
    v_exp_f32 v51, v51
    v_exp_f32 v52, v52
    v_exp_f32 v53, v53
    v_exp_f32 v54, v54
    v_exp_f32 v55, v55
    v_exp_f32 v56, v56
    v_exp_f32 v57, v57
    v_exp_f32 v58, v58
    v_exp_f32 v59, v59
    v_exp_f32 v60, v60
    v_exp_f32 v61, v61
    v_exp_f32 v62, v62
    v_exp_f32 v63, v63
    v_add_f32 v48, 1.0, v48
    v_add_f32 v49, 1.0, v49
    v_add_f32 v50, 1.0, v50
    v_add_f32 v51, 1.0, v51
    v_add_f32 v52, 1.0, v52
    v_add_f32 v53, 1.0, v53
    v_add_f32 v54, 1.0, v54
    v_add_f32 v55, 1.0, v55
    v_add_f32 v56, 1.0, v56
    v_add_f32 v57, 1.0, v57
    v_add_f32 v58, 1.0, v58
    v_add_f32 v59, 1.0, v59
    v_add_f32 v60, 1.0, v60
    v_add_f32 v61, 1.0, v61
    v_add_f32 v62, 1.0, v62
    v_add_f32 v63, 1.0, v63
    v_rcp_f32 v48, v48
    v_rcp_f32 v49, v49
    v_rcp_f32 v50, v50
    v_rcp_f32 v51, v51
    v_rcp_f32 v52, v52
    v_rcp_f32 v53, v53
    v_rcp_f32 v54, v54
    v_rcp_f32 v55, v55
    v_rcp_f32 v56, v56
    v_rcp_f32 v57, v57
    v_rcp_f32 v58, v58
    v_rcp_f32 v59, v59
    v_rcp_f32 v60, v60
    v_rcp_f32 v61, v61
    v_rcp_f32 v62, v62
    v_rcp_f32 v63, v63
    v_pk_mul_f32 v[48:49], v[48:49], v[32:33]
    v_pk_mul_f32 v[50:51], v[50:51], v[34:35]
    v_pk_mul_f32 v[52:53], v[52:53], v[36:37]
    v_pk_mul_f32 v[54:55], v[54:55], v[38:39]
    v_pk_mul_f32 v[56:57], v[56:57], v[40:41]
    v_pk_mul_f32 v[58:59], v[58:59], v[42:43]
    v_pk_mul_f32 v[60:61], v[60:61], v[44:45]
    v_pk_mul_f32 v[62:63], v[62:63], v[46:47]
    v_cvt_pk_bf16_f32 v16, v48, v49
    v_cvt_pk_bf16_f32 v17, v50, v51
    v_cvt_pk_bf16_f32 v18, v52, v53
    v_cvt_pk_bf16_f32 v19, v54, v55
    v_cvt_pk_bf16_f32 v20, v56, v57
    v_cvt_pk_bf16_f32 v21, v58, v59
    v_cvt_pk_bf16_f32 v22, v60, v61
    v_cvt_pk_bf16_f32 v23, v62, v63
    buffer_store_dwordx4 v[16:19], v6, s[36:39], s56 offen sc1
    buffer_store_dwordx4 v[20:23], v6, s[36:39], s56 offen offset:2048 sc1
    v_mov_b32 v25, 1
    s_waitcnt vmcnt(0)
    s_mov_b64 exec, 1
    buffer_store_dword v25, v15, s[36:39], s57 offen sc1
    s_mov_b64 exec, -1
K2_G2:
    s_setprio 0
    s_cmp_ge_u32 s34, 28
    s_cbranch_scc1 K2_WEND
K2_G3:
    s_xor_b32 s47, s16, 0
    s_mul_i32 s47, s47, 24576
    s_add_u32 s47, s47, 0
    v_lshl_add_u32 v8, v1, 4, s47
    s_xor_b32 s47, s16, 1
    s_mul_i32 s47, s47, 24576
    s_add_u32 s47, s47, 0
    v_lshl_add_u32 v9, v1, 4, s47
    s_xor_b32 s47, s16, 2
    s_mul_i32 s47, s47, 24576
    s_add_u32 s47, s47, 0
    v_lshl_add_u32 v10, v1, 4, s47
    s_xor_b32 s47, s16, 3
    s_mul_i32 s47, s47, 24576
    s_add_u32 s47, s47, 0
    v_lshl_add_u32 v11, v1, 4, s47
    s_add_u32 m0, s44, 16384
    s_nop 0
    buffer_load_dwordx4 v214, s[84:87], s32 offen lds
    buffer_load_dwordx4 v215, s[84:87], s32 offen offset:1024 lds
    s_add_u32 s32, s32, 65536
    s_add_u32 m0, s44, 18432
    s_nop 0
    buffer_load_dwordx4 v214, s[84:87], s32 offen lds
    buffer_load_dwordx4 v215, s[84:87], s32 offen offset:1024 lds
    s_add_u32 s32, s32, 65536
    s_add_u32 m0, s44, 20480
    s_nop 0
    buffer_load_dwordx4 v214, s[84:87], s32 offen lds
    buffer_load_dwordx4 v215, s[84:87], s32 offen offset:1024 lds
    s_add_u32 s32, s32, 65536
    s_add_u32 m0, s44, 22528
    s_nop 0
    buffer_load_dwordx4 v214, s[84:87], s32 offen lds
    buffer_load_dwordx4 v215, s[84:87], s32 offen offset:1024 lds
    s_add_u32 s32, s32, 65536
    s_add_u32 m0, s44, 0
    s_nop 0
    buffer_load_dwordx4 v214, s[84:87], s32 offen lds
    buffer_load_dwordx4 v215, s[84:87], s32 offen offset:1024 lds
    s_add_u32 s32, s32, 65536
    s_add_u32 m0, s44, 2048
    s_nop 0
    buffer_load_dwordx4 v214, s[84:87], s32 offen lds
    buffer_load_dwordx4 v215, s[84:87], s32 offen offset:1024 lds
    s_add_u32 s32, s32, 65536
    s_add_u32 m0, s44, 4096
    s_nop 0
    buffer_load_dwordx4 v214, s[84:87], s32 offen lds
    buffer_load_dwordx4 v215, s[84:87], s32 offen offset:1024 lds
    s_add_u32 s32, s32, 65536
    s_add_u32 m0, s44, 6144
    s_nop 0
    buffer_load_dwordx4 v214, s[84:87], s32 offen lds
    buffer_load_dwordx4 v215, s[84:87], s32 offen offset:1024 lds
    s_add_u32 s32, s32, 65536
    s_add_u32 m0, s44, 8192
    s_nop 0
    buffer_load_dwordx4 v214, s[84:87], s32 offen lds
    buffer_load_dwordx4 v215, s[84:87], s32 offen offset:1024 lds
    s_add_u32 s32, s32, 65536
    s_add_u32 m0, s44, 10240
    s_nop 0
    buffer_load_dwordx4 v214, s[84:87], s32 offen lds
    buffer_load_dwordx4 v215, s[84:87], s32 offen offset:1024 lds
    s_add_u32 s32, s32, 65536
    s_add_u32 m0, s44, 12288
    s_nop 0
    buffer_load_dwordx4 v214, s[84:87], s32 offen lds
    buffer_load_dwordx4 v215, s[84:87], s32 offen offset:1024 lds
    s_add_u32 s32, s32, 65536
    s_add_u32 m0, s44, 14336
    s_nop 0
    buffer_load_dwordx4 v214, s[84:87], s32 offen lds
    buffer_load_dwordx4 v215, s[84:87], s32 offen offset:1024 lds
    s_add_u32 s32, s32, 65536
    v_min_u32 v25, 27, v1
    v_lshrrev_b32 v3, 2, v25
    v_mul_u32_u24 v3, 128, v3
    v_and_b32 v25, 3, v25
    v_lshl_add_u32 v3, v25, 2, v3
    s_mov_b32 s55, 0x40000
PL4:
    buffer_load_dword v25, v3, s[36:39], s52 offen sc1
    s_waitcnt vmcnt(0)
    v_cmp_eq_u32 vcc, 0, v25
    s_cbranch_vccz PL4D
    s_sleep 2
    s_sub_u32 s55, s55, 1
    s_cbranch_scc0 PL4
PL4D:
    buffer_load_dwordx4 v[176:179], v28, s[36:39], s33 offen sc1
    buffer_load_dwordx4 v[180:183], v29, s[36:39], s33 offen sc1
    s_add_u32 s33, s33, 2048
    buffer_load_dwordx4 v[184:187], v28, s[36:39], s33 offen sc1
    buffer_load_dwordx4 v[188:191], v29, s[36:39], s33 offen sc1
    s_add_u32 s33, s33, 2048
    buffer_load_dwordx4 v[192:195], v28, s[36:39], s33 offen sc1
    buffer_load_dwordx4 v[196:199], v29, s[36:39], s33 offen sc1
    s_add_u32 s33, s33, 2048
    buffer_load_dwordx4 v[200:203], v28, s[36:39], s33 offen sc1
    buffer_load_dwordx4 v[204:207], v29, s[36:39], s33 offen sc1
    s_add_u32 s33, s33, 2048
    buffer_load_dwordx4 v[112:115], v28, s[36:39], s33 offen sc1
    buffer_load_dwordx4 v[116:119], v29, s[36:39], s33 offen sc1
    s_add_u32 s33, s33, 2048
    buffer_load_dwordx4 v[120:123], v28, s[36:39], s33 offen sc1
    buffer_load_dwordx4 v[124:127], v29, s[36:39], s33 offen sc1
    s_add_u32 s33, s33, 2048
    ds_read_b64_tr_b16 v[96:97], v26 offset:16384
    ds_read_b64_tr_b16 v[98:99], v26 offset:17408
    ds_read_b64_tr_b16 v[100:101], v27 offset:16384
    ds_read_b64_tr_b16 v[102:103], v27 offset:17408
    ds_read_b64_tr_b16 v[104:105], v26 offset:18432
    ds_read_b64_tr_b16 v[106:107], v26 offset:19456
    ds_read_b64_tr_b16 v[108:109], v27 offset:18432
    ds_read_b64_tr_b16 v[110:111], v27 offset:19456
    s_waitcnt vmcnt(10)
    s_waitcnt lgkmcnt(4)
    v_mfma_f32_32x32x16_bf16 v[32:47], v[176:179], v[96:99], 0
    v_mfma_f32_32x32x16_bf16 v[48:63], v[176:179], v[100:103], 0
    v_mfma_f32_32x32x16_bf16 v[64:79], v[180:183], v[96:99], 0
    v_mfma_f32_32x32x16_bf16 v[80:95], v[180:183], v[100:103], 0
    buffer_load_dwordx4 v[128:131], v28, s[36:39], s33 offen sc1
    buffer_load_dwordx4 v[132:135], v29, s[36:39], s33 offen sc1
    s_add_u32 s33, s33, 2048
    ds_read_b64_tr_b16 v[96:97], v26 offset:20480
    ds_read_b64_tr_b16 v[98:99], v26 offset:21504
    ds_read_b64_tr_b16 v[100:101], v27 offset:20480
    ds_read_b64_tr_b16 v[102:103], v27 offset:21504
    s_waitcnt vmcnt(10)
    s_waitcnt lgkmcnt(4)
    v_mfma_f32_32x32x16_bf16 v[32:47], v[184:187], v[104:107], v[32:47]
    v_mfma_f32_32x32x16_bf16 v[48:63], v[184:187], v[108:111], v[48:63]
    v_mfma_f32_32x32x16_bf16 v[64:79], v[188:191], v[104:107], v[64:79]
    v_mfma_f32_32x32x16_bf16 v[80:95], v[188:191], v[108:111], v[80:95]
    buffer_load_dwordx4 v[136:139], v28, s[36:39], s33 offen sc1
    buffer_load_dwordx4 v[140:143], v29, s[36:39], s33 offen sc1
    s_add_u32 s33, s33, 2048
    ds_read_b64_tr_b16 v[104:105], v26 offset:22528
    ds_read_b64_tr_b16 v[106:107], v26 offset:23552
    ds_read_b64_tr_b16 v[108:109], v27 offset:22528
    ds_read_b64_tr_b16 v[110:111], v27 offset:23552
    s_waitcnt vmcnt(10)
    s_waitcnt lgkmcnt(4)
    v_mfma_f32_32x32x16_bf16 v[32:47], v[192:195], v[96:99], v[32:47]
    v_mfma_f32_32x32x16_bf16 v[48:63], v[192:195], v[100:103], v[48:63]
    v_mfma_f32_32x32x16_bf16 v[64:79], v[196:199], v[96:99], v[64:79]
    v_mfma_f32_32x32x16_bf16 v[80:95], v[196:199], v[100:103], v[80:95]
    buffer_load_dwordx4 v[144:147], v28, s[36:39], s33 offen sc1
    buffer_load_dwordx4 v[148:151], v29, s[36:39], s33 offen sc1
    s_add_u32 s33, s33, 2048
    ds_read_b64_tr_b16 v[96:97], v26 offset:0
    ds_read_b64_tr_b16 v[98:99], v26 offset:1024
    ds_read_b64_tr_b16 v[100:101], v27 offset:0
    ds_read_b64_tr_b16 v[102:103], v27 offset:1024
    s_waitcnt vmcnt(10)
    s_waitcnt lgkmcnt(4)
    v_mfma_f32_32x32x16_bf16 v[32:47], v[200:203], v[104:107], v[32:47]
    v_mfma_f32_32x32x16_bf16 v[48:63], v[200:203], v[108:111], v[48:63]
    v_mfma_f32_32x32x16_bf16 v[64:79], v[204:207], v[104:107], v[64:79]
    v_mfma_f32_32x32x16_bf16 v[80:95], v[204:207], v[108:111], v[80:95]
    buffer_load_dwordx4 v[152:155], v28, s[36:39], s33 offen sc1
    buffer_load_dwordx4 v[156:159], v29, s[36:39], s33 offen sc1
    s_add_u32 s33, s33, 2048
    ds_read_b64_tr_b16 v[104:105], v26 offset:2048
    ds_read_b64_tr_b16 v[106:107], v26 offset:3072
    ds_read_b64_tr_b16 v[108:109], v27 offset:2048
    ds_read_b64_tr_b16 v[110:111], v27 offset:3072
    s_waitcnt vmcnt(10)
    s_waitcnt lgkmcnt(4)
    v_mfma_f32_32x32x16_bf16 v[32:47], v[112:115], v[96:99], v[32:47]
    v_mfma_f32_32x32x16_bf16 v[48:63], v[112:115], v[100:103], v[48:63]
    v_mfma_f32_32x32x16_bf16 v[64:79], v[116:119], v[96:99], v[64:79]
    v_mfma_f32_32x32x16_bf16 v[80:95], v[116:119], v[100:103], v[80:95]
    buffer_load_dwordx4 v[160:163], v28, s[36:39], s33 offen sc1
    buffer_load_dwordx4 v[164:167], v29, s[36:39], s33 offen sc1
    s_add_u32 s33, s33, 2048
    ds_read_b64_tr_b16 v[96:97], v26 offset:4096
    ds_read_b64_tr_b16 v[98:99], v26 offset:5120
    ds_read_b64_tr_b16 v[100:101], v27 offset:4096
    ds_read_b64_tr_b16 v[102:103], v27 offset:5120
    s_waitcnt vmcnt(10)
    s_waitcnt lgkmcnt(4)
    v_mfma_f32_32x32x16_bf16 v[32:47], v[120:123], v[104:107], v[32:47]
    v_mfma_f32_32x32x16_bf16 v[48:63], v[120:123], v[108:111], v[48:63]
    v_mfma_f32_32x32x16_bf16 v[64:79], v[124:127], v[104:107], v[64:79]
    v_mfma_f32_32x32x16_bf16 v[80:95], v[124:127], v[108:111], v[80:95]
    buffer_load_dwordx4 v[168:171], v28, s[36:39], s33 offen sc1
    buffer_load_dwordx4 v[172:175], v29, s[36:39], s33 offen sc1
    s_add_u32 s33, s33, 2048
    ds_read_b64_tr_b16 v[104:105], v26 offset:6144
    ds_read_b64_tr_b16 v[106:107], v26 offset:7168
    ds_read_b64_tr_b16 v[108:109], v27 offset:6144
    ds_read_b64_tr_b16 v[110:111], v27 offset:7168
    s_waitcnt vmcnt(10)
    s_waitcnt lgkmcnt(4)
    v_mfma_f32_32x32x16_bf16 v[32:47], v[128:131], v[96:99], v[32:47]
    v_mfma_f32_32x32x16_bf16 v[48:63], v[128:131], v[100:103], v[48:63]
    v_mfma_f32_32x32x16_bf16 v[64:79], v[132:135], v[96:99], v[64:79]
    v_mfma_f32_32x32x16_bf16 v[80:95], v[132:135], v[100:103], v[80:95]
    s_add_u32 m0, s44, 16384
    buffer_load_dwordx4 v[176:179], v28, s[36:39], s33 offen sc1
    buffer_load_dwordx4 v214, s[84:87], s32 offen lds
    buffer_load_dwordx4 v[180:183], v29, s[36:39], s33 offen sc1
    s_add_u32 s33, s33, 2048
    buffer_load_dwordx4 v215, s[84:87], s32 offen offset:1024 lds
    s_add_u32 s32, s32, 65536
    ds_read_b64_tr_b16 v[96:97], v26 offset:8192
    ds_read_b64_tr_b16 v[98:99], v26 offset:9216
    ds_read_b64_tr_b16 v[100:101], v27 offset:8192
    ds_read_b64_tr_b16 v[102:103], v27 offset:9216
    s_waitcnt vmcnt(12)
    s_waitcnt lgkmcnt(4)
    v_mfma_f32_32x32x16_bf16 v[32:47], v[136:139], v[104:107], v[32:47]
    v_mfma_f32_32x32x16_bf16 v[48:63], v[136:139], v[108:111], v[48:63]
    v_mfma_f32_32x32x16_bf16 v[64:79], v[140:143], v[104:107], v[64:79]
    v_mfma_f32_32x32x16_bf16 v[80:95], v[140:143], v[108:111], v[80:95]
    s_add_u32 m0, s44, 18432
    buffer_load_dwordx4 v[184:187], v28, s[36:39], s33 offen sc1
    buffer_load_dwordx4 v214, s[84:87], s32 offen lds
    buffer_load_dwordx4 v[188:191], v29, s[36:39], s33 offen sc1
    s_add_u32 s33, s33, 2048
    buffer_load_dwordx4 v215, s[84:87], s32 offen offset:1024 lds
    s_add_u32 s32, s32, 65536
    ds_read_b64_tr_b16 v[104:105], v26 offset:10240
    ds_read_b64_tr_b16 v[106:107], v26 offset:11264
    ds_read_b64_tr_b16 v[108:109], v27 offset:10240
    ds_read_b64_tr_b16 v[110:111], v27 offset:11264
    s_waitcnt vmcnt(14)
    s_waitcnt lgkmcnt(4)
    v_mfma_f32_32x32x16_bf16 v[32:47], v[144:147], v[96:99], v[32:47]
    v_mfma_f32_32x32x16_bf16 v[48:63], v[144:147], v[100:103], v[48:63]
    v_mfma_f32_32x32x16_bf16 v[64:79], v[148:151], v[96:99], v[64:79]
    v_mfma_f32_32x32x16_bf16 v[80:95], v[148:151], v[100:103], v[80:95]
    s_add_u32 m0, s44, 20480
    buffer_load_dwordx4 v[192:195], v28, s[36:39], s33 offen sc1
    buffer_load_dwordx4 v214, s[84:87], s32 offen lds
    buffer_load_dwordx4 v[196:199], v29, s[36:39], s33 offen sc1
    s_add_u32 s33, s33, 2048
    buffer_load_dwordx4 v215, s[84:87], s32 offen offset:1024 lds
    s_add_u32 s32, s32, 65536
    ds_read_b64_tr_b16 v[96:97], v26 offset:12288
    ds_read_b64_tr_b16 v[98:99], v26 offset:13312
    ds_read_b64_tr_b16 v[100:101], v27 offset:12288
    ds_read_b64_tr_b16 v[102:103], v27 offset:13312
    s_waitcnt vmcnt(16)
    s_waitcnt lgkmcnt(4)
    v_mfma_f32_32x32x16_bf16 v[32:47], v[152:155], v[104:107], v[32:47]
    v_mfma_f32_32x32x16_bf16 v[48:63], v[152:155], v[108:111], v[48:63]
    v_mfma_f32_32x32x16_bf16 v[64:79], v[156:159], v[104:107], v[64:79]
    v_mfma_f32_32x32x16_bf16 v[80:95], v[156:159], v[108:111], v[80:95]
    s_add_u32 m0, s44, 22528
    buffer_load_dwordx4 v[200:203], v28, s[36:39], s33 offen sc1
    buffer_load_dwordx4 v214, s[84:87], s32 offen lds
    buffer_load_dwordx4 v[204:207], v29, s[36:39], s33 offen sc1
    s_add_u32 s33, s33, 2048
    buffer_load_dwordx4 v215, s[84:87], s32 offen offset:1024 lds
    s_add_u32 s32, s32, 65536
    ds_read_b64_tr_b16 v[104:105], v26 offset:14336
    ds_read_b64_tr_b16 v[106:107], v26 offset:15360
    ds_read_b64_tr_b16 v[108:109], v27 offset:14336
    ds_read_b64_tr_b16 v[110:111], v27 offset:15360
    s_waitcnt vmcnt(18)
    s_waitcnt lgkmcnt(4)
    v_mfma_f32_32x32x16_bf16 v[32:47], v[160:163], v[96:99], v[32:47]
    v_mfma_f32_32x32x16_bf16 v[48:63], v[160:163], v[100:103], v[48:63]
    v_mfma_f32_32x32x16_bf16 v[64:79], v[164:167], v[96:99], v[64:79]
    v_mfma_f32_32x32x16_bf16 v[80:95], v[164:167], v[100:103], v[80:95]
    s_add_u32 m0, s44, 0
    buffer_load_dwordx4 v[112:115], v28, s[36:39], s33 offen sc1
    buffer_load_dwordx4 v214, s[84:87], s32 offen lds
    buffer_load_dwordx4 v[116:119], v29, s[36:39], s33 offen sc1
    s_add_u32 s33, s33, 2048
    buffer_load_dwordx4 v215, s[84:87], s32 offen offset:1024 lds
    s_add_u32 s32, s32, 65536
    s_waitcnt vmcnt(16)
    ds_read_b64_tr_b16 v[96:97], v26 offset:16384
    ds_read_b64_tr_b16 v[98:99], v26 offset:17408
    ds_read_b64_tr_b16 v[100:101], v27 offset:16384
    ds_read_b64_tr_b16 v[102:103], v27 offset:17408
    s_waitcnt lgkmcnt(4)
    v_mfma_f32_32x32x16_bf16 v[32:47], v[168:171], v[104:107], v[32:47]
    v_mfma_f32_32x32x16_bf16 v[48:63], v[168:171], v[108:111], v[48:63]
    v_mfma_f32_32x32x16_bf16 v[64:79], v[172:175], v[104:107], v[64:79]
    v_mfma_f32_32x32x16_bf16 v[80:95], v[172:175], v[108:111], v[80:95]
    s_add_u32 m0, s44, 2048
    buffer_load_dwordx4 v[120:123], v28, s[36:39], s33 offen sc1
    buffer_load_dwordx4 v214, s[84:87], s32 offen lds
    buffer_load_dwordx4 v[124:127], v29, s[36:39], s33 offen sc1
    s_add_u32 s33, s33, 2048
    buffer_load_dwordx4 v215, s[84:87], s32 offen offset:1024 lds
    s_add_u32 s32, s32, 65536
    s_waitcnt vmcnt(16)
    ds_read_b64_tr_b16 v[104:105], v26 offset:18432
    ds_read_b64_tr_b16 v[106:107], v26 offset:19456
    ds_read_b64_tr_b16 v[108:109], v27 offset:18432
    ds_read_b64_tr_b16 v[110:111], v27 offset:19456
    s_waitcnt lgkmcnt(4)
    v_mfma_f32_32x32x16_bf16 v[32:47], v[176:179], v[96:99], v[32:47]
    v_mfma_f32_32x32x16_bf16 v[48:63], v[176:179], v[100:103], v[48:63]
    v_mfma_f32_32x32x16_bf16 v[64:79], v[180:183], v[96:99], v[64:79]
    v_mfma_f32_32x32x16_bf16 v[80:95], v[180:183], v[100:103], v[80:95]
    s_add_u32 m0, s44, 4096
    buffer_load_dwordx4 v[128:131], v28, s[36:39], s33 offen sc1
    buffer_load_dwordx4 v214, s[84:87], s32 offen lds
    buffer_load_dwordx4 v[132:135], v29, s[36:39], s33 offen sc1
    s_add_u32 s33, s33, 2048
    buffer_load_dwordx4 v215, s[84:87], s32 offen offset:1024 lds
    s_add_u32 s32, s32, 65536
    s_waitcnt vmcnt(16)
    ds_read_b64_tr_b16 v[96:97], v26 offset:20480
    ds_read_b64_tr_b16 v[98:99], v26 offset:21504
    ds_read_b64_tr_b16 v[100:101], v27 offset:20480
    ds_read_b64_tr_b16 v[102:103], v27 offset:21504
    s_waitcnt lgkmcnt(4)
    v_mfma_f32_32x32x16_bf16 v[32:47], v[184:187], v[104:107], v[32:47]
    v_mfma_f32_32x32x16_bf16 v[48:63], v[184:187], v[108:111], v[48:63]
    v_mfma_f32_32x32x16_bf16 v[64:79], v[188:191], v[104:107], v[64:79]
    v_mfma_f32_32x32x16_bf16 v[80:95], v[188:191], v[108:111], v[80:95]
    s_add_u32 m0, s44, 6144
    buffer_load_dwordx4 v[136:139], v28, s[36:39], s33 offen sc1
    buffer_load_dwordx4 v214, s[84:87], s32 offen lds
    buffer_load_dwordx4 v[140:143], v29, s[36:39], s33 offen sc1
    s_add_u32 s33, s33, 2048
    buffer_load_dwordx4 v215, s[84:87], s32 offen offset:1024 lds
    s_add_u32 s32, s32, 65536
    s_waitcnt vmcnt(16)
    ds_read_b64_tr_b16 v[104:105], v26 offset:22528
    ds_read_b64_tr_b16 v[106:107], v26 offset:23552
    ds_read_b64_tr_b16 v[108:109], v27 offset:22528
    ds_read_b64_tr_b16 v[110:111], v27 offset:23552
    s_waitcnt lgkmcnt(4)
    v_mfma_f32_32x32x16_bf16 v[32:47], v[192:195], v[96:99], v[32:47]
    v_mfma_f32_32x32x16_bf16 v[48:63], v[192:195], v[100:103], v[48:63]
    v_mfma_f32_32x32x16_bf16 v[64:79], v[196:199], v[96:99], v[64:79]
    v_mfma_f32_32x32x16_bf16 v[80:95], v[196:199], v[100:103], v[80:95]
    s_add_u32 m0, s44, 8192
    buffer_load_dwordx4 v[144:147], v28, s[36:39], s33 offen sc1
    buffer_load_dwordx4 v214, s[84:87], s32 offen lds
    buffer_load_dwordx4 v[148:151], v29, s[36:39], s33 offen sc1
    s_add_u32 s33, s33, 2048
    buffer_load_dwordx4 v215, s[84:87], s32 offen offset:1024 lds
    s_add_u32 s32, s32, 65536
    s_waitcnt vmcnt(16)
    ds_read_b64_tr_b16 v[96:97], v26 offset:0
    ds_read_b64_tr_b16 v[98:99], v26 offset:1024
    ds_read_b64_tr_b16 v[100:101], v27 offset:0
    ds_read_b64_tr_b16 v[102:103], v27 offset:1024
    s_waitcnt lgkmcnt(4)
    v_mfma_f32_32x32x16_bf16 v[32:47], v[200:203], v[104:107], v[32:47]
    v_mfma_f32_32x32x16_bf16 v[48:63], v[200:203], v[108:111], v[48:63]
    v_mfma_f32_32x32x16_bf16 v[64:79], v[204:207], v[104:107], v[64:79]
    v_mfma_f32_32x32x16_bf16 v[80:95], v[204:207], v[108:111], v[80:95]
    s_add_u32 m0, s44, 10240
    buffer_load_dwordx4 v[152:155], v28, s[36:39], s33 offen sc1
    buffer_load_dwordx4 v214, s[84:87], s32 offen lds
    buffer_load_dwordx4 v[156:159], v29, s[36:39], s33 offen sc1
    s_add_u32 s33, s33, 2048
    buffer_load_dwordx4 v215, s[84:87], s32 offen offset:1024 lds
    s_add_u32 s32, s32, 65536
    s_waitcnt vmcnt(16)
    ds_read_b64_tr_b16 v[104:105], v26 offset:2048
    ds_read_b64_tr_b16 v[106:107], v26 offset:3072
    ds_read_b64_tr_b16 v[108:109], v27 offset:2048
    ds_read_b64_tr_b16 v[110:111], v27 offset:3072
    s_waitcnt lgkmcnt(4)
    v_mfma_f32_32x32x16_bf16 v[32:47], v[112:115], v[96:99], v[32:47]
    v_mfma_f32_32x32x16_bf16 v[48:63], v[112:115], v[100:103], v[48:63]
    v_mfma_f32_32x32x16_bf16 v[64:79], v[116:119], v[96:99], v[64:79]
    v_mfma_f32_32x32x16_bf16 v[80:95], v[116:119], v[100:103], v[80:95]
    s_add_u32 m0, s44, 12288
    buffer_load_dwordx4 v[160:163], v28, s[36:39], s33 offen sc1
    buffer_load_dwordx4 v214, s[84:87], s32 offen lds
    buffer_load_dwordx4 v[164:167], v29, s[36:39], s33 offen sc1
    s_add_u32 s33, s33, 2048
    buffer_load_dwordx4 v215, s[84:87], s32 offen offset:1024 lds
    s_add_u32 s32, s32, 65536
    v_min_u32 v217, 7, v1
    v_lshrrev_b32 v216, 2, v217
    v_mul_u32_u24 v216, 512, v216
    v_and_b32 v217, 3, v217
    v_lshl_add_u32 v216, v217, 2, v216
    buffer_load_dword v217, v216, s[36:39], s53 offen sc1
    s_waitcnt vmcnt(17)
    ds_read_b64_tr_b16 v[96:97], v26 offset:4096
    ds_read_b64_tr_b16 v[98:99], v26 offset:5120
    ds_read_b64_tr_b16 v[100:101], v27 offset:4096
    ds_read_b64_tr_b16 v[102:103], v27 offset:5120
    s_waitcnt lgkmcnt(4)
    v_mfma_f32_32x32x16_bf16 v[32:47], v[120:123], v[104:107], v[32:47]
    v_mfma_f32_32x32x16_bf16 v[48:63], v[120:123], v[108:111], v[48:63]
    v_mfma_f32_32x32x16_bf16 v[64:79], v[124:127], v[104:107], v[64:79]
    v_mfma_f32_32x32x16_bf16 v[80:95], v[124:127], v[108:111], v[80:95]
    s_add_u32 m0, s44, 14336
    buffer_load_dwordx4 v[168:171], v28, s[36:39], s33 offen sc1
    buffer_load_dwordx4 v214, s[84:87], s32 offen lds
    buffer_load_dwordx4 v[172:175], v29, s[36:39], s33 offen sc1
    s_add_u32 s33, s33, 2048
    buffer_load_dwordx4 v215, s[84:87], s32 offen offset:1024 lds
    s_add_u32 s32, s32, 65536
    s_waitcnt vmcnt(17)
    ds_read_b64_tr_b16 v[104:105], v26 offset:6144
    ds_read_b64_tr_b16 v[106:107], v26 offset:7168
    ds_read_b64_tr_b16 v[108:109], v27 offset:6144
    ds_read_b64_tr_b16 v[110:111], v27 offset:7168
    s_waitcnt lgkmcnt(4)
    v_mfma_f32_32x32x16_bf16 v[32:47], v[128:131], v[96:99], v[32:47]
    v_mfma_f32_32x32x16_bf16 v[48:63], v[128:131], v[100:103], v[48:63]
    v_mfma_f32_32x32x16_bf16 v[64:79], v[132:135], v[96:99], v[64:79]
    v_mfma_f32_32x32x16_bf16 v[80:95], v[132:135], v[100:103], v[80:95]
    s_add_u32 m0, s44, 16384
    buffer_load_dwordx4 v[176:179], v28, s[36:39], s33 offen sc1
    buffer_load_dwordx4 v214, s[84:87], s32 offen lds
    buffer_load_dwordx4 v[180:183], v29, s[36:39], s33 offen sc1
    s_add_u32 s33, s33, 2048
    buffer_load_dwordx4 v215, s[84:87], s32 offen offset:1024 lds
    s_add_u32 s32, s32, 65536
    s_waitcnt vmcnt(17)
    ds_read_b64_tr_b16 v[96:97], v26 offset:8192
    ds_read_b64_tr_b16 v[98:99], v26 offset:9216
    ds_read_b64_tr_b16 v[100:101], v27 offset:8192
    ds_read_b64_tr_b16 v[102:103], v27 offset:9216
    s_waitcnt lgkmcnt(4)
    v_mfma_f32_32x32x16_bf16 v[32:47], v[136:139], v[104:107], v[32:47]
    v_mfma_f32_32x32x16_bf16 v[48:63], v[136:139], v[108:111], v[48:63]
    v_mfma_f32_32x32x16_bf16 v[64:79], v[140:143], v[104:107], v[64:79]
    v_mfma_f32_32x32x16_bf16 v[80:95], v[140:143], v[108:111], v[80:95]
    s_add_u32 m0, s44, 18432
    buffer_load_dwordx4 v[184:187], v28, s[36:39], s33 offen sc1
    buffer_load_dwordx4 v214, s[84:87], s32 offen lds
    buffer_load_dwordx4 v[188:191], v29, s[36:39], s33 offen sc1
    s_add_u32 s33, s33, 2048
    buffer_load_dwordx4 v215, s[84:87], s32 offen offset:1024 lds
    s_add_u32 s32, s32, 65536
    s_waitcnt vmcnt(17)
    ds_read_b64_tr_b16 v[104:105], v26 offset:10240
    ds_read_b64_tr_b16 v[106:107], v26 offset:11264
    ds_read_b64_tr_b16 v[108:109], v27 offset:10240
    ds_read_b64_tr_b16 v[110:111], v27 offset:11264
    s_waitcnt lgkmcnt(4)
    v_mfma_f32_32x32x16_bf16 v[32:47], v[144:147], v[96:99], v[32:47]
    v_mfma_f32_32x32x16_bf16 v[48:63], v[144:147], v[100:103], v[48:63]
    v_mfma_f32_32x32x16_bf16 v[64:79], v[148:151], v[96:99], v[64:79]
    v_mfma_f32_32x32x16_bf16 v[80:95], v[148:151], v[100:103], v[80:95]
    s_add_u32 m0, s44, 20480
    buffer_load_dwordx4 v[192:195], v28, s[36:39], s33 offen sc1
    buffer_load_dwordx4 v214, s[84:87], s32 offen lds
    buffer_load_dwordx4 v[196:199], v29, s[36:39], s33 offen sc1
    s_add_u32 s33, s33, 2048
    buffer_load_dwordx4 v215, s[84:87], s32 offen offset:1024 lds
    s_add_u32 s32, s32, 65536
    s_waitcnt vmcnt(17)
    ds_read_b64_tr_b16 v[96:97], v26 offset:12288
    ds_read_b64_tr_b16 v[98:99], v26 offset:13312
    ds_read_b64_tr_b16 v[100:101], v27 offset:12288
    ds_read_b64_tr_b16 v[102:103], v27 offset:13312
    s_waitcnt lgkmcnt(4)
    v_mfma_f32_32x32x16_bf16 v[32:47], v[152:155], v[104:107], v[32:47]
    v_mfma_f32_32x32x16_bf16 v[48:63], v[152:155], v[108:111], v[48:63]
    v_mfma_f32_32x32x16_bf16 v[64:79], v[156:159], v[104:107], v[64:79]
    v_mfma_f32_32x32x16_bf16 v[80:95], v[156:159], v[108:111], v[80:95]
    s_add_u32 m0, s44, 22528
    buffer_load_dwordx4 v[200:203], v28, s[36:39], s33 offen sc1
    buffer_load_dwordx4 v214, s[84:87], s32 offen lds
    buffer_load_dwordx4 v[204:207], v29, s[36:39], s33 offen sc1
    s_add_u32 s33, s33, 2048
    buffer_load_dwordx4 v215, s[84:87], s32 offen offset:1024 lds
    s_add_u32 s32, s32, 65536
    s_waitcnt vmcnt(16)
    ds_read_b64_tr_b16 v[104:105], v26 offset:14336
    ds_read_b64_tr_b16 v[106:107], v26 offset:15360
    ds_read_b64_tr_b16 v[108:109], v27 offset:14336
    ds_read_b64_tr_b16 v[110:111], v27 offset:15360
    s_waitcnt lgkmcnt(4)
    v_mfma_f32_32x32x16_bf16 v[32:47], v[160:163], v[96:99], v[32:47]
    v_mfma_f32_32x32x16_bf16 v[48:63], v[160:163], v[100:103], v[48:63]
    v_mfma_f32_32x32x16_bf16 v[64:79], v[164:167], v[96:99], v[64:79]
    v_mfma_f32_32x32x16_bf16 v[80:95], v[164:167], v[100:103], v[80:95]
    v_cmp_eq_u32 vcc, 0, v217
    s_cbranch_vccz PL6D
    s_mov_b32 s55, 0x40000
PL6:
    buffer_load_dword v217, v216, s[36:39], s53 offen sc1
    s_waitcnt vmcnt(0)
    v_cmp_eq_u32 vcc, 0, v217
    s_cbranch_vccz PL6D
    s_sleep 2
    s_sub_u32 s55, s55, 1
    s_cbranch_scc0 PL6
PL6D:
    s_add_u32 m0, s44, 0
    buffer_load_dwordx4 v[112:115], v6, s[36:39], s49 offen sc1
    buffer_load_dwordx4 v30, s[76:79], s48 offen lds
    buffer_load_dwordx4 v[116:119], v7, s[36:39], s49 offen sc1
    s_add_u32 s49, s49, 2048
    buffer_load_dwordx4 v31, s[76:79], s48 offen offset:1024 lds
    s_add_u32 s48, s48, 14336
    s_waitcnt vmcnt(16)
    ds_read_b64_tr_b16 v[96:97], v26 offset:16384
    ds_read_b64_tr_b16 v[98:99], v26 offset:17408
    ds_read_b64_tr_b16 v[100:101], v27 offset:16384
    ds_read_b64_tr_b16 v[102:103], v27 offset:17408
    s_waitcnt lgkmcnt(4)
    v_mfma_f32_32x32x16_bf16 v[32:47], v[168:171], v[104:107], v[32:47]
    v_mfma_f32_32x32x16_bf16 v[48:63], v[168:171], v[108:111], v[48:63]
    v_mfma_f32_32x32x16_bf16 v[64:79], v[172:175], v[104:107], v[64:79]
    v_mfma_f32_32x32x16_bf16 v[80:95], v[172:175], v[108:111], v[80:95]
    s_add_u32 m0, s44, 2048
    buffer_load_dwordx4 v[120:123], v6, s[36:39], s49 offen sc1
    buffer_load_dwordx4 v30, s[76:79], s48 offen lds
    buffer_load_dwordx4 v[124:127], v7, s[36:39], s49 offen sc1
    s_add_u32 s49, s49, 2048
    buffer_load_dwordx4 v31, s[76:79], s48 offen offset:1024 lds
    s_add_u32 s48, s48, 10752
    s_waitcnt vmcnt(16)
    ds_read_b64_tr_b16 v[104:105], v26 offset:18432
    ds_read_b64_tr_b16 v[106:107], v26 offset:19456
    ds_read_b64_tr_b16 v[108:109], v27 offset:18432
    ds_read_b64_tr_b16 v[110:111], v27 offset:19456
    s_waitcnt lgkmcnt(4)
    v_mfma_f32_32x32x16_bf16 v[32:47], v[176:179], v[96:99], v[32:47]
    v_mfma_f32_32x32x16_bf16 v[48:63], v[176:179], v[100:103], v[48:63]
    v_mfma_f32_32x32x16_bf16 v[64:79], v[180:183], v[96:99], v[64:79]
    v_mfma_f32_32x32x16_bf16 v[80:95], v[180:183], v[100:103], v[80:95]
    s_add_u32 m0, s44, 4096
    buffer_load_dwordx4 v[128:131], v6, s[36:39], s49 offen sc1
    buffer_load_dwordx4 v30, s[76:79], s48 offen lds
    buffer_load_dwordx4 v[132:135], v7, s[36:39], s49 offen sc1
    s_add_u32 s49, s49, 2048
    buffer_load_dwordx4 v31, s[76:79], s48 offen offset:1024 lds
    s_add_u32 s48, s48, 14336
    s_waitcnt vmcnt(16)
    ds_read_b64_tr_b16 v[96:97], v26 offset:20480
    ds_read_b64_tr_b16 v[98:99], v26 offset:21504
    ds_read_b64_tr_b16 v[100:101], v27 offset:20480
    ds_read_b64_tr_b16 v[102:103], v27 offset:21504
    s_waitcnt lgkmcnt(4)
    v_mfma_f32_32x32x16_bf16 v[32:47], v[184:187], v[104:107], v[32:47]
    v_mfma_f32_32x32x16_bf16 v[48:63], v[184:187], v[108:111], v[48:63]
    v_mfma_f32_32x32x16_bf16 v[64:79], v[188:191], v[104:107], v[64:79]
    v_mfma_f32_32x32x16_bf16 v[80:95], v[188:191], v[108:111], v[80:95]
    s_add_u32 m0, s44, 6144
    buffer_load_dwordx4 v[136:139], v6, s[36:39], s49 offen sc1
    buffer_load_dwordx4 v30, s[76:79], s48 offen lds
    buffer_load_dwordx4 v[140:143], v7, s[36:39], s49 offen sc1
    s_add_u32 s49, s49, 2048
    buffer_load_dwordx4 v31, s[76:79], s48 offen offset:1024 lds
    s_add_u32 s48, s48, 10752
    s_waitcnt vmcnt(16)
    ds_read_b64_tr_b16 v[104:105], v26 offset:22528
    ds_read_b64_tr_b16 v[106:107], v26 offset:23552
    ds_read_b64_tr_b16 v[108:109], v27 offset:22528
    ds_read_b64_tr_b16 v[110:111], v27 offset:23552
    s_waitcnt lgkmcnt(4)
    v_mfma_f32_32x32x16_bf16 v[32:47], v[192:195], v[96:99], v[32:47]
    v_mfma_f32_32x32x16_bf16 v[48:63], v[192:195], v[100:103], v[48:63]
    v_mfma_f32_32x32x16_bf16 v[64:79], v[196:199], v[96:99], v[64:79]
    v_mfma_f32_32x32x16_bf16 v[80:95], v[196:199], v[100:103], v[80:95]
    s_add_u32 m0, s44, 8192
    buffer_load_dwordx4 v[144:147], v6, s[36:39], s49 offen sc1
    buffer_load_dwordx4 v30, s[76:79], s48 offen lds
    buffer_load_dwordx4 v[148:151], v7, s[36:39], s49 offen sc1
    s_add_u32 s49, s49, 2048
    buffer_load_dwordx4 v31, s[76:79], s48 offen offset:1024 lds
    s_add_u32 s48, s48, 14336
    s_waitcnt vmcnt(16)
    ds_read_b64_tr_b16 v[96:97], v12 offset:0
    ds_read_b64_tr_b16 v[98:99], v12 offset:1024
    ds_read_b64_tr_b16 v[100:101], v13 offset:0
    ds_read_b64_tr_b16 v[102:103], v13 offset:1024
    s_waitcnt lgkmcnt(4)
    v_mfma_f32_32x32x16_bf16 v[32:47], v[200:203], v[104:107], v[32:47]
    v_mfma_f32_32x32x16_bf16 v[48:63], v[200:203], v[108:111], v[48:63]
    v_mfma_f32_32x32x16_bf16 v[64:79], v[204:207], v[104:107], v[64:79]
    v_mfma_f32_32x32x16_bf16 v[80:95], v[204:207], v[108:111], v[80:95]
    s_add_u32 m0, s44, 10240
    buffer_load_dwordx4 v[152:155], v6, s[36:39], s49 offen sc1
    buffer_load_dwordx4 v30, s[76:79], s48 offen lds
    buffer_load_dwordx4 v[156:159], v7, s[36:39], s49 offen sc1
    s_add_u32 s49, s49, 2048
    buffer_load_dwordx4 v31, s[76:79], s48 offen offset:1024 lds
    s_add_u32 s48, s48, 10752
    v_sub_f32 v208, 1.0, v208
    v_sub_f32 v210, 1.0, v209
    s_nop 7
    s_nop 1
    v_pk_mul_f32 v[32:33], v[32:33], v[208:209] op_sel_hi:[1,0]
    v_pk_mul_f32 v[34:35], v[34:35], v[208:209] op_sel_hi:[1,0]
    v_pk_mul_f32 v[36:37], v[36:37], v[208:209] op_sel_hi:[1,0]
    v_pk_mul_f32 v[38:39], v[38:39], v[208:209] op_sel_hi:[1,0]
    v_pk_mul_f32 v[40:41], v[40:41], v[208:209] op_sel_hi:[1,0]
    v_pk_mul_f32 v[42:43], v[42:43], v[208:209] op_sel_hi:[1,0]
    v_pk_mul_f32 v[44:45], v[44:45], v[208:209] op_sel_hi:[1,0]
    v_pk_mul_f32 v[46:47], v[46:47], v[208:209] op_sel_hi:[1,0]
    v_pk_mul_f32 v[48:49], v[48:49], v[210:211] op_sel_hi:[1,0]
    v_pk_mul_f32 v[50:51], v[50:51], v[210:211] op_sel_hi:[1,0]
    v_pk_mul_f32 v[52:53], v[52:53], v[210:211] op_sel_hi:[1,0]
    v_pk_mul_f32 v[54:55], v[54:55], v[210:211] op_sel_hi:[1,0]
    v_pk_mul_f32 v[56:57], v[56:57], v[210:211] op_sel_hi:[1,0]
    v_pk_mul_f32 v[58:59], v[58:59], v[210:211] op_sel_hi:[1,0]
    v_pk_mul_f32 v[60:61], v[60:61], v[210:211] op_sel_hi:[1,0]
    v_pk_mul_f32 v[62:63], v[62:63], v[210:211] op_sel_hi:[1,0]
    v_pk_mul_f32 v[64:65], v[64:65], v[208:209] op_sel_hi:[1,0]
    v_pk_mul_f32 v[66:67], v[66:67], v[208:209] op_sel_hi:[1,0]
    v_pk_mul_f32 v[68:69], v[68:69], v[208:209] op_sel_hi:[1,0]
    v_pk_mul_f32 v[70:71], v[70:71], v[208:209] op_sel_hi:[1,0]
    v_pk_mul_f32 v[72:73], v[72:73], v[208:209] op_sel_hi:[1,0]
    v_pk_mul_f32 v[74:75], v[74:75], v[208:209] op_sel_hi:[1,0]
    v_pk_mul_f32 v[76:77], v[76:77], v[208:209] op_sel_hi:[1,0]
    v_pk_mul_f32 v[78:79], v[78:79], v[208:209] op_sel_hi:[1,0]
    v_pk_mul_f32 v[80:81], v[80:81], v[210:211] op_sel_hi:[1,0]
    v_pk_mul_f32 v[82:83], v[82:83], v[210:211] op_sel_hi:[1,0]
    v_pk_mul_f32 v[84:85], v[84:85], v[210:211] op_sel_hi:[1,0]
    v_pk_mul_f32 v[86:87], v[86:87], v[210:211] op_sel_hi:[1,0]
    v_pk_mul_f32 v[88:89], v[88:89], v[210:211] op_sel_hi:[1,0]
    v_pk_mul_f32 v[90:91], v[90:91], v[210:211] op_sel_hi:[1,0]
    v_pk_mul_f32 v[92:93], v[92:93], v[210:211] op_sel_hi:[1,0]
    v_pk_mul_f32 v[94:95], v[94:95], v[210:211] op_sel_hi:[1,0]
    v_lshlrev_b32 v212, 16, v212
    v_mul_f32 v212, v212, v208
    v_mul_u32_u24 v24, 896, v213
    v_lshrrev_b32 v3, 5, v1
    v_lshl_add_u32 v24, v3, 4, v24
    s_mul_i32 s46, s30, 57344
    s_lshl_b32 s47, s31, 7
    s_add_u32 s46, s46, s47
    s_lshl_b32 s47, s42, 6
    s_add_u32 s46, s46, s47
    v_pk_add_f32 v[32:33], v[32:33], v[212:213] op_sel_hi:[1,0]
    v_pk_add_f32 v[34:35], v[34:35], v[212:213] op_sel_hi:[1,0]
    v_pk_add_f32 v[36:37], v[36:37], v[212:213] op_sel_hi:[1,0]
    v_pk_add_f32 v[38:39], v[38:39], v[212:213] op_sel_hi:[1,0]
    v_pk_add_f32 v[40:41], v[40:41], v[212:213] op_sel_hi:[1,0]
    v_pk_add_f32 v[42:43], v[42:43], v[212:213] op_sel_hi:[1,0]
    v_pk_add_f32 v[44:45], v[44:45], v[212:213] op_sel_hi:[1,0]
    v_pk_add_f32 v[46:47], v[46:47], v[212:213] op_sel_hi:[1,0]
    s_waitcnt vmcnt(16)
    ds_read_b64_tr_b16 v[104:105], v12 offset:2048
    ds_read_b64_tr_b16 v[106:107], v12 offset:3072
    ds_read_b64_tr_b16 v[108:109], v13 offset:2048
    ds_read_b64_tr_b16 v[110:111], v13 offset:3072
    s_waitcnt lgkmcnt(4)
    v_mfma_f32_32x32x16_bf16 v[32:47], v[96:99], v[112:115], v[32:47]
    v_mfma_f32_32x32x16_bf16 v[48:63], v[96:99], v[116:119], v[48:63]
    v_mfma_f32_32x32x16_bf16 v[64:79], v[100:103], v[112:115], v[64:79]
    v_mfma_f32_32x32x16_bf16 v[80:95], v[100:103], v[116:119], v[80:95]
    s_add_u32 m0, s44, 12288
    buffer_load_dwordx4 v[160:163], v6, s[36:39], s49 offen sc1
    buffer_load_dwordx4 v30, s[76:79], s48 offen lds
    buffer_load_dwordx4 v[164:167], v7, s[36:39], s49 offen sc1
    s_add_u32 s49, s49, 2048
    buffer_load_dwordx4 v31, s[76:79], s48 offen offset:1024 lds
    s_add_u32 s48, s48, 14336
    s_waitcnt vmcnt(16)
    ds_read_b64_tr_b16 v[96:97], v12 offset:4096
    ds_read_b64_tr_b16 v[98:99], v12 offset:5120
    ds_read_b64_tr_b16 v[100:101], v13 offset:4096
    ds_read_b64_tr_b16 v[102:103], v13 offset:5120
    s_waitcnt lgkmcnt(4)
    v_mfma_f32_32x32x16_bf16 v[32:47], v[104:107], v[120:123], v[32:47]
    v_mfma_f32_32x32x16_bf16 v[48:63], v[104:107], v[124:127], v[48:63]
    v_mfma_f32_32x32x16_bf16 v[64:79], v[108:111], v[120:123], v[64:79]
    v_mfma_f32_32x32x16_bf16 v[80:95], v[108:111], v[124:127], v[80:95]
    s_add_u32 m0, s44, 14336
    buffer_load_dwordx4 v[168:171], v6, s[36:39], s49 offen sc1
    buffer_load_dwordx4 v30, s[76:79], s48 offen lds
    buffer_load_dwordx4 v[172:175], v7, s[36:39], s49 offen sc1
    s_add_u32 s49, s49, 2048
    buffer_load_dwordx4 v31, s[76:79], s48 offen offset:1024 lds
    s_add_u32 s48, s48, 10752
    s_waitcnt vmcnt(16)
    ds_read_b64_tr_b16 v[104:105], v12 offset:6144
    ds_read_b64_tr_b16 v[106:107], v12 offset:7168
    ds_read_b64_tr_b16 v[108:109], v13 offset:6144
    ds_read_b64_tr_b16 v[110:111], v13 offset:7168
    s_waitcnt lgkmcnt(4)
    v_mfma_f32_32x32x16_bf16 v[32:47], v[96:99], v[128:131], v[32:47]
    v_mfma_f32_32x32x16_bf16 v[48:63], v[96:99], v[132:135], v[48:63]
    v_mfma_f32_32x32x16_bf16 v[64:79], v[100:103], v[128:131], v[64:79]
    v_mfma_f32_32x32x16_bf16 v[80:95], v[100:103], v[132:135], v[80:95]
    s_waitcnt vmcnt(12)
    ds_read_b64_tr_b16 v[96:97], v12 offset:8192
    ds_read_b64_tr_b16 v[98:99], v12 offset:9216
    ds_read_b64_tr_b16 v[100:101], v13 offset:8192
    ds_read_b64_tr_b16 v[102:103], v13 offset:9216
    s_waitcnt lgkmcnt(4)
    v_mfma_f32_32x32x16_bf16 v[32:47], v[104:107], v[136:139], v[32:47]
    v_mfma_f32_32x32x16_bf16 v[48:63], v[104:107], v[140:143], v[48:63]
    v_mfma_f32_32x32x16_bf16 v[64:79], v[108:111], v[136:139], v[64:79]
    v_mfma_f32_32x32x16_bf16 v[80:95], v[108:111], v[140:143], v[80:95]
    s_waitcnt vmcnt(8)
    ds_read_b64_tr_b16 v[104:105], v12 offset:10240
    ds_read_b64_tr_b16 v[106:107], v12 offset:11264
    ds_read_b64_tr_b16 v[108:109], v13 offset:10240
    ds_read_b64_tr_b16 v[110:111], v13 offset:11264
    s_waitcnt lgkmcnt(4)
    v_mfma_f32_32x32x16_bf16 v[32:47], v[96:99], v[144:147], v[32:47]
    v_mfma_f32_32x32x16_bf16 v[48:63], v[96:99], v[148:151], v[48:63]
    v_mfma_f32_32x32x16_bf16 v[64:79], v[100:103], v[144:147], v[64:79]
    v_mfma_f32_32x32x16_bf16 v[80:95], v[100:103], v[148:151], v[80:95]
    s_waitcnt vmcnt(4)
    ds_read_b64_tr_b16 v[96:97], v12 offset:12288
    ds_read_b64_tr_b16 v[98:99], v12 offset:13312
    ds_read_b64_tr_b16 v[100:101], v13 offset:12288
    ds_read_b64_tr_b16 v[102:103], v13 offset:13312
    s_waitcnt lgkmcnt(4)
    v_mfma_f32_32x32x16_bf16 v[32:47], v[104:107], v[152:155], v[32:47]
    v_mfma_f32_32x32x16_bf16 v[48:63], v[104:107], v[156:159], v[48:63]
    v_mfma_f32_32x32x16_bf16 v[64:79], v[108:111], v[152:155], v[64:79]
    v_mfma_f32_32x32x16_bf16 v[80:95], v[108:111], v[156:159], v[80:95]
    s_waitcnt vmcnt(0)
    ds_read_b64_tr_b16 v[104:105], v12 offset:14336
    ds_read_b64_tr_b16 v[106:107], v12 offset:15360
    ds_read_b64_tr_b16 v[108:109], v13 offset:14336
    ds_read_b64_tr_b16 v[110:111], v13 offset:15360
    s_waitcnt lgkmcnt(4)
    v_mfma_f32_32x32x16_bf16 v[32:47], v[96:99], v[160:163], v[32:47]
    v_mfma_f32_32x32x16_bf16 v[48:63], v[96:99], v[164:167], v[48:63]
    v_mfma_f32_32x32x16_bf16 v[64:79], v[100:103], v[160:163], v[64:79]
    v_mfma_f32_32x32x16_bf16 v[80:95], v[100:103], v[164:167], v[80:95]
    s_waitcnt lgkmcnt(0)
    v_mfma_f32_32x32x16_bf16 v[32:47], v[104:107], v[168:171], v[32:47]
    v_mfma_f32_32x32x16_bf16 v[48:63], v[104:107], v[172:175], v[48:63]
    v_mfma_f32_32x32x16_bf16 v[64:79], v[108:111], v[168:171], v[64:79]
    v_mfma_f32_32x32x16_bf16 v[80:95], v[108:111], v[172:175], v[80:95]
    s_nop 7
    s_nop 4
    ds_write_b128 v8, v[48:51] offset:4096
    ds_write_b128 v8, v[52:55] offset:5120
    ds_write_b128 v8, v[56:59] offset:6144
    ds_write_b128 v8, v[60:63] offset:7168
    ds_write_b128 v8, v[64:67] offset:8192
    ds_write_b128 v8, v[68:71] offset:9216
    ds_write_b128 v8, v[72:75] offset:10240
    ds_write_b128 v8, v[76:79] offset:11264
    ds_write_b128 v8, v[80:83] offset:12288
    ds_write_b128 v8, v[84:87] offset:13312
    ds_write_b128 v8, v[88:91] offset:14336
    ds_write_b128 v8, v[92:95] offset:15360
    s_cbranch_execz K2_NOAR
    v_mov_b32 v25, 1
    s_waitcnt lgkmcnt(0)
    s_mov_b64 exec, 1
    ds_add_u32 v14, v25 offset:12
    s_mov_b64 exec, -1
LW7:
    ds_read_b32 v25, v14 offset:12
    s_waitcnt lgkmcnt(0)
    v_readfirstlane_b32 s54, v25
    s_cmp_lt_u32 s54, 4
    s_cbranch_scc1 LW7
K2_NOAR:
    ds_read_b128 v[48:51], v9 offset:4096
    ds_read_b128 v[52:55], v9 offset:5120
    ds_read_b128 v[56:59], v9 offset:6144
    ds_read_b128 v[60:63], v9 offset:7168
    ds_read_b128 v[64:67], v10 offset:8192
    ds_read_b128 v[68:71], v10 offset:9216
    ds_read_b128 v[72:75], v10 offset:10240
    ds_read_b128 v[76:79], v10 offset:11264
    ds_read_b128 v[80:83], v11 offset:12288
    ds_read_b128 v[84:87], v11 offset:13312
    ds_read_b128 v[88:91], v11 offset:14336
    ds_read_b128 v[92:95], v11 offset:15360
    s_waitcnt lgkmcnt(8)
    v_pk_add_f32 v[32:33], v[32:33], v[48:49]
    v_pk_add_f32 v[34:35], v[34:35], v[50:51]
    v_pk_add_f32 v[36:37], v[36:37], v[52:53]
    v_pk_add_f32 v[38:39], v[38:39], v[54:55]
    v_pk_add_f32 v[40:41], v[40:41], v[56:57]
    v_pk_add_f32 v[42:43], v[42:43], v[58:59]
    v_pk_add_f32 v[44:45], v[44:45], v[60:61]
    v_pk_add_f32 v[46:47], v[46:47], v[62:63]
    s_waitcnt lgkmcnt(4)
    v_pk_add_f32 v[32:33], v[32:33], v[64:65]
    v_pk_add_f32 v[34:35], v[34:35], v[66:67]
    v_pk_add_f32 v[36:37], v[36:37], v[68:69]
    v_pk_add_f32 v[38:39], v[38:39], v[70:71]
    v_pk_add_f32 v[40:41], v[40:41], v[72:73]
    v_pk_add_f32 v[42:43], v[42:43], v[74:75]
    v_pk_add_f32 v[44:45], v[44:45], v[76:77]
    v_pk_add_f32 v[46:47], v[46:47], v[78:79]
    s_waitcnt lgkmcnt(0)
    v_pk_add_f32 v[32:33], v[32:33], v[80:81]
    v_pk_add_f32 v[34:35], v[34:35], v[82:83]
    v_pk_add_f32 v[36:37], v[36:37], v[84:85]
    v_pk_add_f32 v[38:39], v[38:39], v[86:87]
    v_pk_add_f32 v[40:41], v[40:41], v[88:89]
    v_pk_add_f32 v[42:43], v[42:43], v[90:91]
    v_pk_add_f32 v[44:45], v[44:45], v[92:93]
    v_pk_add_f32 v[46:47], v[46:47], v[94:95]
    v_cvt_pk_bf16_f32 v48, v32, v33
    v_cvt_pk_bf16_f32 v49, v34, v35
    v_cvt_pk_bf16_f32 v50, v36, v37
    v_cvt_pk_bf16_f32 v51, v38, v39
    v_cvt_pk_bf16_f32 v52, v40, v41
    v_cvt_pk_bf16_f32 v53, v42, v43
    v_cvt_pk_bf16_f32 v54, v44, v45
    v_cvt_pk_bf16_f32 v55, v46, v47
    s_nop 1
    v_permlane32_swap_b32 v48, v50
    v_permlane32_swap_b32 v49, v51
    v_permlane32_swap_b32 v52, v54
    v_permlane32_swap_b32 v53, v55
    buffer_store_dwordx4 v[48:51], v24, s[80:83], s46 offen offset:0
    buffer_store_dwordx4 v[52:55], v24, s[80:83], s46 offen offset:32
    s_add_u32 s16, s16, 4
K2_FIN:
K2_END:
    s_endpgm
K2_PF:
    s_lshr_b32 s17, s2, 3
    s_cmp_lt_u32 s17, 25
    s_cbranch_scc1 K2_PFD
    s_lshl_b32 s17, s17, 2
    s_add_u32 s17, s17, s16
    s_sub_u32 s17, s17, 100
    s_and_b32 s18, s2, 7
    s_mov_b32 s20, s4
    s_mov_b32 s21, s5
    s_mov_b32 s22, 7340032
    s_mov_b32 s23, 0x20000
    s_lshl_b32 s45, s17, 16
    s_add_u32 s45, s45, 2383872
    s_lshr_b32 s46, s17, 2
    s_lshl_b32 s47, s16, 5
    s_add_u32 s46, s46, s47
    s_add_u32 s46, s46, 11
    s_mul_i32 s46, s46, 57344
    s_mul_i32 s47, s18, 7
    s_lshr_b32 s47, s47, 1
    s_lshl_b32 s47, s47, 7
    s_add_u32 s46, s46, s47
    v_lshrrev_b32 v3, 2, v1
    v_mul_u32_u24 v3, 3584, v3
    v_and_b32 v4, 3, v1
    v_lshl_add_u32 v3, v4, 7, v3
    v_lshlrev_b32 v4, 7, v1
    buffer_load_dword v44, v3, s[20:23], s46 offen
    s_add_u32 s46, s46, 401408
    buffer_load_dword v47, v3, s[20:23], s46 offen
    s_add_u32 s46, s46, 401408
    buffer_load_dword v50, v3, s[20:23], s46 offen
    s_add_u32 s46, s46, 401408
    s_mul_i32 s19, s17, 14336
    s_lshl_b32 s18, s18, 9
    s_lshl_b32 s17, s17, 18
    s_add_u32 s17, s17, s18
    v_lshrrev_b32 v3, 2, v1
    v_lshlrev_b32 v3, 12, v3
    v_and_b32 v4, 3, v1
    v_lshl_add_u32 v3, v4, 7, v3
    v_lshlrev_b32 v4, 7, v1
    s_mov_b32 s20, s8
    s_mov_b32 s21, s9
    s_mov_b32 s22, 7340032
    s_mov_b32 s23, 0x20000
    buffer_load_dword v32, v3, s[20:23], s17 offen
    s_add_u32 s17, s17, 65536
    buffer_load_dword v33, v3, s[20:23], s17 offen
    s_add_u32 s17, s17, 65536
    buffer_load_dword v34, v3, s[20:23], s17 offen
    s_add_u32 s17, s17, 65536
    buffer_load_dword v35, v3, s[20:23], s17 offen
    s_add_u32 s17, s17, 65536
K2_PFD:
    v_mov_b32 v25, 1
    s_waitcnt lgkmcnt(0)
    s_mov_b64 exec, 1
    ds_add_u32 v14, v25 offset:4
    s_mov_b64 exec, -1
    s_lshr_b32 s34, s2, 3
    s_sub_u32 s34, 31, s34
    s_mul_i32 s30, s34, 9363
    s_lshr_b32 s30, s30, 16
    s_mul_i32 s31, s30, 7
    s_sub_u32 s31, s34, s31
    s_and_b32 s45, s2, 7
    s_lshl_b32 s45, s45, 2
    s_add_u32 s30, s30, s45
    s_mul_i32 s32, s16, 1835008
    s_lshl_b32 s45, s30, 7
    s_add_u32 s32, s32, s45
    s_mul_i32 s33, s31, 229376
    s_mul_i32 s46, s16, 57344
    s_add_u32 s33, s33, s46
    s_add_u32 s33, s33, 4259840
    s_mul_i32 s48, s16, 100352
    s_lshl_b32 s46, s31, 7
    s_add_u32 s48, s48, s46
    s_lshl_b32 s49, s30, 16
    s_lshl_b32 s46, s16, 14
    s_add_u32 s49, s49, s46
    s_add_u32 s49, s49, 6291456
    s_lshl_b32 s52, s31, 2
    s_add_u32 s52, s52, s16
    s_mul_i32 s52, s52, 896
    s_add_u32 s52, s52, 5898240
    s_lshl_b32 s53, s30, 3
    s_add_u32 s53, s53, s16
    s_lshl_b32 s53, s53, 7
    s_add_u32 s53, s53, 5931008
    s_lshl_b32 s46, s42, 10
    v_add_u32 v28, s46, v2
    v_xor_b32 v29, 1024, v28
    v_lshrrev_b32 v3, 3, v1
    s_mov_b32 s47, 4096
    v_mul_lo_u32 v214, v3, s47
    v_lshlrev_b32 v3, 1, v3
    v_and_b32 v3, 4, v3
    v_xor_b32 v3, v3, v1
    v_and_b32 v3, 7, v3
    v_lshl_add_u32 v214, v3, 4, v214
    v_add_u32 v215, 31744, v214
    s_mov_b32 s84, s8
    s_mov_b32 s85, s9
    s_mov_b32 s86, 7340032
    s_mov_b32 s87, 0x20000
    s_mov_b32 s24, s10
    s_mov_b32 s25, s11
    s_mov_b32 s26, 4096
    s_mov_b32 s27, 0x20000
    s_cmp_lt_u32 s34, 28
    s_cselect_b32 s86, s86, 0
    v_and_b32 v3, 31, v1
    s_lshl_b32 s46, s43, 5
    v_add_u32 v213, s46, v3
    v_lshlrev_b32 v208, 2, v213
    v_xor_b32 v209, 128, v208
    v_lshlrev_b32 v212, 1, v213
    s_lshl_b32 s46, s30, 8
    s_add_u32 s46, s46, 4194304
    buffer_load_dword v208, v208, s[36:39], s46 offen
    buffer_load_dword v209, v209, s[36:39], s46 offen
    buffer_load_ushort v212, v212, s[24:27], s45 offen
    v_lshrrev_b32 v3, 5, v1
    v_lshlrev_b32 v26, 9, v3
    v_bfe_u32 v3, v1, 2, 2
    v_lshl_add_u32 v26, v3, 7, v26
    v_lshrrev_b32 v3, 1, v3
    v_xor_b32 v3, s43, v3
    v_lshl_add_u32 v26, v3, 6, v26
    v_bfe_u32 v3, v1, 4, 1
    v_lshl_add_u32 v26, v3, 5, v26
    v_and_b32 v3, 3, v1
    v_lshl_add_u32 v26, v3, 3, v26
    v_add_u32 v26, s44, v26
    v_xor_b32 v27, 64, v26
    v_lshrrev_b32 v3, 3, v1
    s_mov_b32 s47, 896
    v_mul_lo_u32 v30, v3, s47
    v_lshlrev_b32 v3, 1, v3
    v_and_b32 v3, 4, v3
    v_xor_b32 v3, v3, v1
    v_and_b32 v3, 7, v3
    v_lshl_add_u32 v30, v3, 4, v30
    v_add_u32 v31, 6144, v30
    s_branch K2_G2
K2_WEND:
    s_waitcnt vmcnt(0)
    s_endpgm
.section .rodata,"a"
.p2align 6
.amdhsa_kernel k1_kernel
  .amdhsa_next_free_vgpr 80
  .amdhsa_next_free_sgpr 96
  .amdhsa_accum_offset 80
  .amdhsa_group_segment_fixed_size 0
  .amdhsa_kernarg_size 112
  .amdhsa_user_sgpr_count 2
  .amdhsa_user_sgpr_kernarg_segment_ptr 1
  .amdhsa_system_sgpr_workgroup_id_x 1
.end_amdhsa_kernel
.amdhsa_kernel k2_kernel
  .amdhsa_next_free_vgpr 224
  .amdhsa_next_free_sgpr 96
  .amdhsa_accum_offset 224
  .amdhsa_group_segment_fixed_size 0
  .amdhsa_kernarg_size 112
  .amdhsa_user_sgpr_count 2
  .amdhsa_user_sgpr_kernarg_segment_ptr 1
  .amdhsa_system_sgpr_workgroup_id_x 1
.end_amdhsa_kernel
```
